```python
import torch

def _softmax(x, axis=-1):
    return torch.softmax(x, dim=axis)
def _gelu(x):
    return torch.nn.functional.gelu(x, approximate="tanh")
def _silu(x):
    return torch.nn.functional.silu(x)
def _sigmoid(x):
    return torch.sigmoid(x)
def _layernorm(x, axis=-1, eps=1e-5):
    m = x.mean(dim=axis, keepdim=True)
    v = x.var(dim=axis, keepdim=True, unbiased=False)
    return (x - m) / torch.sqrt(v + eps)
def _scatter_add(tgt, idx, src, axis=0):
    return tgt.clone().index_add_(axis, idx, src)
def _segment_sum(src, seg, n):
    out = torch.zeros((n,) + src.shape[1:], dtype=src.dtype)
    return out.index_add_(0, seg, src)
def _pad(x, pw):
    flat = tuple(v for pair in reversed(pw) for v in pair)
    return torch.nn.functional.pad(x, flat)

kernel_name = 'recurrent_scan__gqa_block_cached__glu_gated_swiglu__decode'

def setup_inputs():

    _w = (lambda a: (lambda t: t.to(torch.bfloat16) if t.is_floating_point() else t)(torch.as_tensor(a)))
    def _A_setup():
        B, Sq, D = 1, 1, 1024
        Hq, Hkv, Sk, Dh = 32, 4, 65536, 128
        assert Hq % Hkv == 0, (Hq, Hkv)
        return {
            "x": _w((lambda *s: torch.randn(*s, dtype=torch.bfloat16) * 0.4)(B, Sq, D)),
            "k_cache": _w((lambda *s: torch.randn(*s, dtype=torch.bfloat16) * 1.6)(B, Hkv, Sk, Dh)),
            "v_cache": _w((lambda *s: torch.randn(*s, dtype=torch.bfloat16) * 1.6)(B, Hkv, Sk, Dh)),
            "wq": _w((lambda *s: torch.randn(*s, dtype=torch.bfloat16) * 1.6)(D, Hq * Dh) * (D ** -0.5)),
            "wo": _w((lambda *s: torch.randn(*s, dtype=torch.bfloat16) * 1.6)(Hq * Dh, D) * ((Hq * Dh) ** -0.5)),
        }
    _A_in = _A_setup()

    def _B_setup():
        B, S, D, F = 1, 1, 1024, 3584
        return {
            "x": _w((lambda *s: torch.randn(*s, dtype=torch.bfloat16) * 0.4)(B, S, D)),
            "w1": _w((lambda *s: torch.randn(*s, dtype=torch.bfloat16) * 1.6)(D, F) * (2.0 / D) ** 0.5),
            "w3": _w((lambda *s: torch.randn(*s, dtype=torch.bfloat16) * 1.6)(D, F) * (2.0 / D) ** 0.5),
            "w2": _w((lambda *s: torch.randn(*s, dtype=torch.bfloat16) * 1.6)(F, D) * (2.0 / F) ** 0.5),
        }
    _B_in = _B_setup()

    return {
        "A_x": _A_in["x"],
        "A_k_cache": _A_in["k_cache"],
        "A_v_cache": _A_in["v_cache"],
        "A_wq": _A_in["wq"],
        "A_wo": _A_in["wo"],
        "B_x": _B_in["x"],
        "B_w1": _B_in["w1"],
        "B_w3": _B_in["w3"],
        "B_w2": _B_in["w2"],
    }

def reference(A_x, A_k_cache, A_v_cache, A_wq, A_wo, B_x, B_w1, B_w3, B_w2):
    def _A_ref(x, k_cache, v_cache, wq, wo):
        B, Sq, D = x.shape
        Hq, Dh = 32, 128
        Hkv = k_cache.shape[1]
        rep = Hq // Hkv
        q = (lambda x, *d: x.permute(*d))((x @ wq).reshape(B, Sq, Hq, Dh), 0, 2, 1, 3)
        k = (lambda x, n, axis: torch.repeat_interleave(x, n, dim=axis))(k_cache, rep, axis=1)
        v = (lambda x, n, axis: torch.repeat_interleave(x, n, dim=axis))(v_cache, rep, axis=1)
        scores = torch.einsum("bhqd,bhkd->bhqk", q, k) * (Dh ** -0.5)
        p = _softmax(scores, axis=-1)
        o = torch.einsum("bhqk,bhkd->bhqd", p, v)
        return (lambda x, *d: x.permute(*d))(o, 0, 2, 1, 3).reshape(B, Sq, Hq * Dh) @ wo

    def _B_ref(x, w1, w3, w2):
        gate = torch.einsum("bsd,df->bsf", x, w1)
        up = torch.einsum("bsd,df->bsf", x, w3)
        h = _silu(gate) * up
        out = torch.einsum("bsf,fd->bsd", h, w2)
        return out

    x = A_x
    xn = _layernorm(x, axis=-1)
    s = _A_ref(xn, A_k_cache, A_v_cache, A_wq, A_wo)
    g = _silu(_B_ref(xn, B_w1, B_w3, B_w2))
    return x + s * g
```

```asm
; @launch grid=(256,1,1) block=(512,1,1) lds=61440
.amdgcn_target "amdgcn-amd-amdhsa--gfx950"

.text
.globl recurrent_scan__gqa_block_cached__glu_gated_swiglu__decode_kernel
.p2align 8
.type recurrent_scan__gqa_block_cached__glu_gated_swiglu__decode_kernel,@function
recurrent_scan__gqa_block_cached__glu_gated_swiglu__decode_kernel:
    s_cmp_ge_u32 s2, 256
    s_cbranch_scc1 L_end
    s_load_dwordx2 s[4:5], s[0:1], 0
    s_load_dwordx2 s[16:17], s[0:1], 24
    s_and_b32 s66, s2, 7
    s_lshr_b32 s65, s2, 3
    v_and_b32 v12, 0x1f0, v0
    v_and_b32 v6, 15, v0
    v_lshrrev_b32 v13, 4, v0
    v_lshlrev_b32 v12, 11, v12
    s_lshl_b32 s69, s66, 20
    s_lshl_b32 s70, s65, 8
    s_or_b32 s69, s69, s70
    v_lshl_add_u32 v3, v6, 4, v12
    s_lshl_b32 s70, s66, 8
    v_add_u32 v3, s69, v3
    v_lshl_add_u32 v11, v13, 3, s70
    v_lshrrev_b32 v14, 6, v0
    v_and_b32 v0, 63, v0
    s_movk_i32 s6, 2048
    s_mov_b32 s7, 0x20000
    v_lshlrev_b32 v10, 5, v0
    s_mov_b32 s18, 8388608
    s_mov_b32 s19, s7
    s_movk_i32 s73, 8192
    s_movk_i32 s74, 16384
    s_movk_i32 s75, 24576
    v_mov_b32 v13, 0
    ds_write_b32 v13, v13 offset:23808
    s_waitcnt lgkmcnt(0)
    buffer_load_dwordx4 v[80:83], v3, s[16:19], 0 offen nt
    buffer_load_dwordx4 v[84:87], v3, s[16:19], s73 offen nt
    buffer_load_dwordx4 v[64:67], v10, s[4:7], 0 offen
    buffer_load_dwordx4 v[68:71], v10, s[4:7], 0 offen offset:16
    buffer_load_dwordx2 v[72:73], v11, s[4:7], 0 offen
    buffer_load_dwordx4 v[88:91], v3, s[16:19], s74 offen nt
    buffer_load_dwordx4 v[92:95], v3, s[16:19], s75 offen nt
    s_load_dwordx2 s[36:37], s[0:1], 88
    s_load_dwordx2 s[20:21], s[0:1], 48
    s_load_dwordx2 s[24:25], s[0:1], 56
    s_load_dwordx2 s[8:9], s[0:1], 8
    s_load_dwordx2 s[12:13], s[0:1], 16
    s_load_dwordx2 s[28:29], s[0:1], 64
    s_load_dwordx2 s[32:33], s[0:1], 32
    s_load_dwordx2 s[40:41], s[0:1], 72
    s_load_dwordx2 s[44:45], s[0:1], 80
    v_readfirstlane_b32 s3, v14
    v_lshrrev_b32 v5, 4, v0
    s_mov_b32 s55, 0xffff0000
    s_mov_b32 s38, 268435456
    s_mov_b32 s39, 0x20000
    s_mov_b32 s46, 256
    s_mov_b32 s47, 0x20000
    s_cmp_lt_u32 s65, 28
    s_cselect_b32 s22, 7340032, 0
    s_mov_b32 s26, s22
    s_mov_b32 s23, 0x20000
    s_mov_b32 s27, 0x20000
    v_lshlrev_b32 v8, 3, v0
    s_and_b32 s71, s65, 28
    s_add_u32 s69, s65, 1
    s_and_b32 s69, s69, 3
    s_or_b32 s72, s69, s71
    s_add_u32 s69, s65, 2
    s_and_b32 s69, s69, 3
    s_or_b32 s1, s69, s71
    s_lshl_b32 s69, s66, 7
    s_lshl_b32 s70, s3, 4
    s_add_u32 s69, s69, s70
    s_mul_i32 s69, s69, 7168
    v_mul_u32_u24 v4, 28672, v5
    v_lshl_add_u32 v4, v6, 4, v4
    v_add_u32 v4, s69, v4
    s_lshl_b32 s70, s1, 8
    v_add_u32 v9, s70, v4
    s_lshl_b32 s70, s72, 8
    v_add_u32 v4, s70, v4
    s_movk_i32 s77, 7168
    s_movk_i32 s78, 14336
    s_movk_i32 s79, 21504
    v_and_b32 v13, 1, v6
    v_lshlrev_b32 v13, 4, v13
    v_mov_b32 v14, 0xffff
    v_lshlrev_b32 v13, v13, v14
    v_lshrrev_b32 v14, 1, v6
    v_cmp_eq_u32 vcc, 0, v14
    v_cmp_eq_u32 s[62:63], 1, v14
    v_cmp_eq_u32 s[70:71], 2, v14
    v_cndmask_b32 v16, 0, v13, vcc
    v_cmp_eq_u32 vcc, 3, v14
    v_cndmask_b32 v17, 0, v13, s[62:63]
    v_cndmask_b32 v18, 0, v13, s[70:71]
    v_cndmask_b32 v19, 0, v13, vcc
    s_lshl_b32 s69, s3, 9
    v_lshlrev_b32 v7, 5, v6
    v_lshl_add_u32 v7, v5, 4, v7
    v_add_u32 v7, s69, v7
    s_waitcnt lgkmcnt(0)
    s_cmp_eq_u32 s3, 0
    s_cbranch_scc0 L_role_1
    s_lshr_b32 s69, s2, 6
    s_lshl_b32 s69, s69, 11
    s_and_b32 s70, s2, 63
    s_lshl_b32 s70, s70, 4
    s_add_u32 s69, s69, s70
    s_add_u32 s69, s69, 393216
    v_and_b32 v13, 1, v0
    v_lshl_add_u32 v13, v13, 10, s69
    v_lshrrev_b32 v14, 1, v0
    v_lshl_add_u32 v13, v14, 13, v13
    v_mov_b32 v76, -1
    v_mov_b32 v77, -1
    v_mov_b32 v78, -1
    v_mov_b32 v79, -1
    s_mov_b64 exec, 15
    buffer_store_dwordx4 v[76:79], v13, s[36:39], 0 offen sc1
    s_mov_b64 exec, -1
L_role_1:
    s_or_b32 s69, s2, s3
    s_cmp_eq_u32 s69, 0
    s_cbranch_scc0 L_zc_2
    v_lshlrev_b32 v13, 7, v0
    v_add_u32 v13, 458752, v13
    v_mov_b32 v14, 0
    buffer_store_dword v14, v13, s[36:39], 0 offen sc1
    v_add_u32 v13, 8192, v13
    s_mov_b32 exec_hi, 0
    buffer_store_dword v14, v13, s[36:39], 0 offen sc1
    s_mov_b32 exec_hi, -1
L_zc_2:
    s_waitcnt vmcnt(6)
    buffer_load_dwordx4 v[96:99], v4, s[20:23], 0 offen nt
    s_waitcnt vmcnt(6)
    buffer_load_dwordx4 v[100:103], v4, s[20:23], s77 offen nt
    s_waitcnt vmcnt(4)
    v_mov_b32 v50, 0x3f803f80
    v_dot2_f32_bf16 v48, v64, v50, 0
    v_dot2_f32_bf16 v49, v64, v64, 0
    v_dot2_f32_bf16 v48, v65, v50, v48
    v_dot2_f32_bf16 v49, v65, v65, v49
    v_dot2_f32_bf16 v48, v66, v50, v48
    v_dot2_f32_bf16 v49, v66, v66, v49
    v_dot2_f32_bf16 v48, v67, v50, v48
    v_dot2_f32_bf16 v49, v67, v67, v49
    v_dot2_f32_bf16 v48, v68, v50, v48
    v_dot2_f32_bf16 v49, v68, v68, v49
    v_dot2_f32_bf16 v48, v69, v50, v48
    v_dot2_f32_bf16 v49, v69, v69, v49
    v_dot2_f32_bf16 v48, v70, v50, v48
    v_dot2_f32_bf16 v49, v70, v70, v49
    v_dot2_f32_bf16 v48, v71, v50, v48
    v_dot2_f32_bf16 v49, v71, v71, v49
    v_lshlrev_b32 v52, 16, v72
    v_and_b32 v53, s55, v72
    v_lshlrev_b32 v54, 16, v73
    v_and_b32 v55, s55, v73
    v_add_f32_dpp v48, v48, v48 row_ror:8 row_mask:0xf bank_mask:0xf
    v_add_f32_dpp v49, v49, v49 row_ror:8 row_mask:0xf bank_mask:0xf
    s_nop 0
    v_add_f32_dpp v48, v48, v48 row_ror:4 row_mask:0xf bank_mask:0xf
    v_add_f32_dpp v49, v49, v49 row_ror:4 row_mask:0xf bank_mask:0xf
    s_nop 0
    v_add_f32_dpp v48, v48, v48 row_ror:2 row_mask:0xf bank_mask:0xf
    v_add_f32_dpp v49, v49, v49 row_ror:2 row_mask:0xf bank_mask:0xf
    s_nop 0
    v_add_f32_dpp v48, v48, v48 row_ror:1 row_mask:0xf bank_mask:0xf
    v_add_f32_dpp v49, v49, v49 row_ror:1 row_mask:0xf bank_mask:0xf
    v_mov_b32 v50, v48
    v_mov_b32 v51, v49
    s_nop 0
    v_permlane16_swap_b32 v48, v50
    v_permlane16_swap_b32 v49, v51
    v_add_f32 v48, v48, v50
    v_add_f32 v49, v49, v51
    v_mov_b32 v50, v48
    v_mov_b32 v51, v49
    s_nop 0
    v_permlane32_swap_b32 v48, v50
    v_permlane32_swap_b32 v49, v51
    v_add_f32 v48, v48, v50
    v_add_f32 v49, v49, v51
    v_mul_f32 v48, 0x3a800000, v48
    v_mul_f32 v49, 0x3a800000, v49
    v_fma_f32 v49, -v48, v48, v49
    v_max_f32 v49, 0, v49
    v_cvt_pk_bf16_f32 v48, v48, v48
    v_and_b32 v48, s55, v48
    v_cvt_pk_bf16_f32 v49, v49, v49
    v_and_b32 v49, s55, v49
    v_add_f32 v49, 0x3727c5ac, v49
    v_sub_f32 v52, v52, v48
    v_sub_f32 v53, v53, v48
    v_sub_f32 v54, v54, v48
    v_sub_f32 v55, v55, v48
    v_cvt_pk_bf16_f32 v49, v49, v49
    v_and_b32 v49, s55, v49
    v_sqrt_f32 v49, v49
    v_cvt_pk_bf16_f32 v52, v52, v52
    v_and_b32 v52, s55, v52
    v_cvt_pk_bf16_f32 v53, v53, v53
    v_and_b32 v53, s55, v53
    v_cvt_pk_bf16_f32 v54, v54, v54
    v_and_b32 v54, s55, v54
    v_cvt_pk_bf16_f32 v55, v55, v55
    v_and_b32 v55, s55, v55
    v_cvt_pk_bf16_f32 v49, v49, v49
    v_and_b32 v49, s55, v49
    v_rcp_f32 v51, v49
    s_nop 0
    v_mul_f32 v56, v52, v51
    v_mul_f32 v57, v53, v51
    v_mul_f32 v58, v54, v51
    v_mul_f32 v59, v55, v51
    v_fma_f32 v52, -v56, v49, v52
    v_fma_f32 v53, -v57, v49, v53
    v_fma_f32 v54, -v58, v49, v54
    v_fma_f32 v55, -v59, v49, v55
    v_fmac_f32 v56, v52, v51
    v_fmac_f32 v57, v53, v51
    v_fmac_f32 v58, v54, v51
    v_fmac_f32 v59, v55, v51
    v_cvt_pk_bf16_f32 v56, v56, v56
    v_cvt_pk_bf16_f32 v57, v57, v57
    v_cvt_pk_bf16_f32 v58, v58, v58
    v_cvt_pk_bf16_f32 v59, v59, v59
    v_and_b32 v32, v56, v16
    v_and_b32 v33, v56, v17
    v_and_b32 v34, v56, v18
    v_and_b32 v35, v56, v19
    v_and_b32 v36, v57, v16
    v_and_b32 v37, v57, v17
    v_and_b32 v38, v57, v18
    v_and_b32 v39, v57, v19
    v_and_b32 v40, v58, v16
    v_and_b32 v41, v58, v17
    v_and_b32 v42, v58, v18
    v_and_b32 v43, v58, v19
    v_and_b32 v44, v59, v16
    v_and_b32 v45, v59, v17
    v_and_b32 v46, v59, v18
    v_and_b32 v47, v59, v19
    v_mfma_f32_16x16x32_bf16 v[48:51], v[32:35], v[80:83], 0
    v_mfma_f32_16x16x32_bf16 v[48:51], v[36:39], v[84:87], v[48:51]
    s_waitcnt vmcnt(3)
    buffer_load_dwordx4 v[104:107], v4, s[20:23], s78 offen nt
    v_mfma_f32_16x16x32_bf16 v[48:51], v[40:43], v[88:91], v[48:51]
    s_waitcnt vmcnt(3)
    buffer_load_dwordx4 v[108:111], v4, s[20:23], s79 offen nt
    v_mfma_f32_16x16x32_bf16 v[48:51], v[44:47], v[92:95], v[48:51]
    s_lshr_b32 s67, s2, 6
    s_and_b32 s68, s2, 63
    s_mov_b32 s10, 67108864
    s_mov_b32 s11, 0x20000
    s_mov_b32 exec_hi, 0
    s_nop 2
    ds_write_b128 v7, v[48:51] offset:0
    s_mov_b32 exec_hi, -1
    s_waitcnt lgkmcnt(0)
    s_barrier
    s_waitcnt vmcnt(3)
    buffer_load_dwordx4 v[112:115], v9, s[24:27], 0 offen nt
    s_cmp_eq_u32 s3, 0
    s_cbranch_scc0 L_role_3
    v_lshlrev_b32 v11, 4, v0
    s_mov_b32 exec_hi, 0
    ds_read_b128 v[224:227], v11 offset:0
    ds_read_b128 v[228:231], v11 offset:512
    ds_read_b128 v[232:235], v11 offset:1024
    ds_read_b128 v[236:239], v11 offset:1536
    ds_read_b128 v[240:243], v11 offset:2048
    ds_read_b128 v[244:247], v11 offset:2560
    ds_read_b128 v[248:251], v11 offset:3072
    ds_read_b128 v[252:255], v11 offset:3584
    s_lshl_b32 s69, s2, 9
    v_add_u32 v10, s69, v11
    s_waitcnt lgkmcnt(0)
    v_add_f32 v224, v224, v228
    v_add_f32 v225, v225, v229
    v_add_f32 v226, v226, v230
    v_add_f32 v227, v227, v231
    v_add_f32 v232, v232, v236
    v_add_f32 v233, v233, v237
    v_add_f32 v234, v234, v238
    v_add_f32 v235, v235, v239
    v_add_f32 v240, v240, v244
    v_add_f32 v241, v241, v245
    v_add_f32 v242, v242, v246
    v_add_f32 v243, v243, v247
    v_add_f32 v248, v248, v252
    v_add_f32 v249, v249, v253
    v_add_f32 v250, v250, v254
    v_add_f32 v251, v251, v255
    v_add_f32 v224, v224, v232
    v_add_f32 v225, v225, v233
    v_add_f32 v226, v226, v234
    v_add_f32 v227, v227, v235
    v_add_f32 v240, v240, v248
    v_add_f32 v241, v241, v249
    v_add_f32 v242, v242, v250
    v_add_f32 v243, v243, v251
    v_add_f32 v224, v224, v240
    v_add_f32 v225, v225, v241
    v_add_f32 v226, v226, v242
    v_add_f32 v227, v227, v243
    buffer_store_dwordx4 v[224:227], v10, s[36:39], 0 offen offset:0 sc1
    s_mov_b32 exec_hi, -1
L_role_3:
    s_lshl_b32 s69, s67, 24
    s_lshl_b32 s70, s68, 15
    s_add_u32 s69, s69, s70
    s_lshl_b32 s70, s3, 12
    s_add_u32 s76, s69, s70
    v_and_b32 v1, 7, v0
    v_lshlrev_b32 v1, 8, v1
    v_bfe_u32 v13, v0, 3, 1
    v_lshl_add_u32 v1, v13, 6, v1
    v_lshl_add_u32 v1, v5, 4, v1
    v_add_u32 v1, s76, v1
    v_lshl_add_u32 v2, v0, 4, s76
    s_waitcnt vmcnt(3)
    buffer_load_dwordx4 v[116:119], v9, s[24:27], s77 offen nt
    s_mov_b32 s48, 2097152
    s_mov_b32 s49, 4194304
    s_mov_b32 s50, 6291456
    s_mov_b32 s51, 8388608
    s_mov_b32 s52, 10485760
    s_mov_b32 s53, 12582912
    s_mov_b32 s54, 14680064
    s_waitcnt vmcnt(3)
    buffer_load_dwordx4 v[120:123], v9, s[24:27], s78 offen nt
    s_waitcnt vmcnt(3)
    buffer_load_dwordx4 v[124:127], v9, s[24:27], s79 offen nt
    v_mfma_f32_16x16x32_bf16 v[52:55], v[32:35], v[96:99], 0
    v_mfma_f32_16x16x32_bf16 v[52:55], v[36:39], v[100:103], v[52:55]
    v_mfma_f32_16x16x32_bf16 v[52:55], v[40:43], v[104:107], v[52:55]
    s_waitcnt vmcnt(3)
    buffer_load_dwordx4 v[128:131], v1, s[8:11], 0 offen offset:0 nt
    v_mfma_f32_16x16x32_bf16 v[52:55], v[44:47], v[108:111], v[52:55]
    s_cmp_eq_u32 s3, 0
    s_cbranch_scc0 L_role_4
    s_waitcnt vmcnt(4)
    s_lshl_b32 s69, s67, 6
    v_mov_b32 v10, s69
    v_mov_b32 v11, 1
    s_mov_b64 exec, 1
    buffer_atomic_add v11, v10, s[44:47], 0 offen offset:0
    s_mov_b64 exec, -1
L_role_4:
    s_waitcnt vmcnt(3)
    buffer_load_dwordx4 v[132:135], v1, s[8:11], 0 offen offset:128 nt
    v_mfma_f32_16x16x32_bf16 v[56:59], v[32:35], v[112:115], 0
    s_waitcnt vmcnt(3)
    buffer_load_dwordx4 v[136:139], v1, s[8:11], 0 offen offset:2048 nt
    v_mfma_f32_16x16x32_bf16 v[56:59], v[36:39], v[116:119], v[56:59]
    s_waitcnt vmcnt(3)
    buffer_load_dwordx4 v[140:143], v1, s[8:11], 0 offen offset:2176 nt
    v_mfma_f32_16x16x32_bf16 v[56:59], v[40:43], v[120:123], v[56:59]
    s_waitcnt vmcnt(3)
    buffer_load_dwordx4 v[144:147], v1, s[8:11], s48 offen offset:0 nt
    v_mfma_f32_16x16x32_bf16 v[56:59], v[44:47], v[124:127], v[56:59]
    s_mov_b32 exec_hi, 0
    ds_write_b128 v7, v[52:55] offset:4096
    s_nop 5
    ds_write_b128 v7, v[56:59] offset:8192
    s_mov_b32 exec_hi, -1
    s_waitcnt vmcnt(3)
    buffer_load_dwordx4 v[148:151], v1, s[8:11], s48 offen offset:128 nt
    s_waitcnt vmcnt(3)
    buffer_load_dwordx4 v[152:155], v1, s[8:11], s48 offen offset:2048 nt
    s_waitcnt vmcnt(3)
    buffer_load_dwordx4 v[156:159], v1, s[8:11], s48 offen offset:2176 nt
    s_mov_b32 s14, 67108864
    s_mov_b32 s15, 0x20000
    s_mov_b32 s30, 7340032
    s_mov_b32 s31, 0x20000
    s_mov_b32 s34, 8388608
    s_mov_b32 s35, 0x20000
    s_mov_b32 s42, 2048
    s_mov_b32 s43, 0x20000
    s_mov_b32 s56, 0x3db504f3
    s_mov_b32 s57, 0x05040100
    s_mov_b32 s58, 0x07060302
    s_mov_b32 s59, 0x3fb8aa3b
    s_mov_b32 s64, 262144
    s_waitcnt vmcnt(3)
    buffer_load_dwordx4 v[160:163], v1, s[8:11], s49 offen offset:0 nt
    s_lshl_b32 s69, s67, 18
    s_lshl_b32 s70, s68, 6
    s_add_u32 s69, s69, s70
    s_add_u32 s77, s69, 1048576
    s_lshl_b32 s69, s67, 11
    s_lshl_b32 s70, s68, 4
    s_add_u32 s69, s69, s70
    s_add_u32 s76, s69, 393216
    s_lshl_b32 s69, s72, 3
    s_or_b32 s69, s69, s66
    s_lshl_b32 s69, s69, 9
    s_add_u32 s72, s69, 131072
    s_lshl_b32 s69, s1, 3
    s_or_b32 s69, s69, s66
    s_lshl_b32 s69, s69, 9
    s_add_u32 s1, s69, 262144
    s_lshl_b32 s65, s67, 3
    s_or_b32 s65, s65, s66
    s_bfe_u32 s68, s2, 0x30003
    s_lshl_b32 s71, s65, 9
    s_lshl_b32 s70, s68, 14
    s_add_u32 s70, s70, s71
    s_add_u32 s78, s70, 524288
    s_xor_b32 s70, s68, 1
    s_lshl_b32 s70, s70, 14
    s_add_u32 s70, s70, s71
    s_add_u32 s0, s70, 655360
    s_waitcnt vmcnt(3)
    buffer_load_dwordx4 v[164:167], v1, s[8:11], s49 offen offset:128 nt
    s_cmp_eq_u32 s3, 5
    s_cbranch_scc0 L_role_5
    v_mov_b32 v76, -1
    v_mov_b32 v77, -1
    v_mov_b32 v78, -1
    v_mov_b32 v79, -1
    v_and_b32 v13, 31, v0
    v_lshlrev_b32 v13, 4, v13
    v_mov_b32 v60, s78
    v_mov_b32 v61, s0
    v_cmp_gt_u32 vcc, 32, v0
    s_nop 1
    v_cndmask_b32 v60, v61, v60, vcc
    v_add_u32 v60, v60, v13
    buffer_store_dwordx4 v[76:79], v60, s[36:39], 0 offen sc1
L_role_5:
    s_lshl_b32 s69, s66, 8
    s_lshl_b32 s70, s67, 6
    s_add_u32 s69, s69, s70
    s_lshl_b32 s70, s68, 3
    s_add_u32 s79, s69, s70
    v_and_b32 v12, 1, v0
    v_lshlrev_b32 v12, 2, v12
    v_and_b32 v13, 2, v0
    v_add3_u32 v12, v12, v13, s79
    buffer_load_ushort v9, v12, s[4:7], 0 offen
    s_waitcnt vmcnt(4)
    buffer_load_dwordx4 v[168:171], v1, s[8:11], s49 offen offset:2048 nt
    s_waitcnt vmcnt(4)
    buffer_load_dwordx4 v[172:175], v1, s[8:11], s49 offen offset:2176 nt
    s_waitcnt vmcnt(4)
    buffer_load_dwordx4 v[176:179], v1, s[8:11], s50 offen offset:0 nt
    s_waitcnt vmcnt(4)
    buffer_load_dwordx4 v[180:183], v1, s[8:11], s50 offen offset:128 nt
    s_waitcnt vmcnt(3)
    buffer_load_dwordx4 v[184:187], v1, s[8:11], s50 offen offset:2048 nt
    s_waitcnt vmcnt(3)
    buffer_load_dwordx4 v[188:191], v1, s[8:11], s50 offen offset:2176 nt
    s_waitcnt vmcnt(3)
    buffer_load_dwordx4 v[192:195], v1, s[8:11], s51 offen offset:0 nt
    s_waitcnt vmcnt(3)
    buffer_load_dwordx4 v[196:199], v1, s[8:11], s51 offen offset:128 nt
    v_lshlrev_b32 v14, 2, v0
    buffer_load_dword v15, v14, s[44:47], 0 offen sc1
    s_waitcnt vmcnt(4)
    buffer_load_dwordx4 v[200:203], v1, s[8:11], s51 offen offset:2048 nt
    s_waitcnt vmcnt(4)
    buffer_load_dwordx4 v[204:207], v1, s[8:11], s51 offen offset:2176 nt
    s_waitcnt vmcnt(4)
    buffer_load_dwordx4 v[208:211], v1, s[8:11], s52 offen offset:0 nt
    s_waitcnt vmcnt(4)
    buffer_load_dwordx4 v[212:215], v1, s[8:11], s52 offen offset:128 nt
    s_waitcnt vmcnt(3)
    buffer_load_dwordx4 v[216:219], v1, s[8:11], s52 offen offset:2048 nt
    s_mov_b32 s60, 0x10001
    s_mov_b32 s61, 0x10001
L_chk_6:
    v_cmp_le_u32 vcc, 64, v15
    s_nop 0
    s_and_b64 s[62:63], vcc, s[60:61]
    s_cmp_eq_u64 s[62:63], s[60:61]
    s_cbranch_scc1 L_ok_7
    s_cmp_eq_u32 s64, 0
    s_cbranch_scc1 L_ok_7
    s_sub_u32 s64, s64, 1
    s_sleep 2
    v_lshlrev_b32 v14, 2, v0
    buffer_load_dword v15, v14, s[44:47], 0 offen sc1
    s_waitcnt vmcnt(0)
    s_branch L_chk_6
L_ok_7:
    s_lshl_b32 s69, s67, 15
    s_lshl_b32 s70, s3, 12
    s_add_u32 s69, s69, s70
    v_lshl_add_u32 v14, v0, 4, s69
    buffer_load_dwordx4 v[32:35], v14, s[36:39], 0 offen offset:0 sc1
    buffer_load_dwordx4 v[36:39], v14, s[36:39], 0 offen offset:1024 sc1
    buffer_load_dwordx4 v[40:43], v14, s[36:39], 0 offen offset:2048 sc1
    buffer_load_dwordx4 v[44:47], v14, s[36:39], 0 offen offset:3072 sc1
    s_waitcnt vmcnt(7)
    buffer_load_dwordx4 v[220:223], v1, s[8:11], s52 offen offset:2176 nt
    s_waitcnt vmcnt(7)
    buffer_load_dwordx4 v[224:227], v1, s[8:11], s53 offen offset:0 nt
    s_waitcnt vmcnt(7)
    buffer_load_dwordx4 v[228:231], v1, s[8:11], s53 offen offset:128 nt
    s_waitcnt vmcnt(7)
    buffer_load_dwordx4 v[232:235], v1, s[8:11], s53 offen offset:2048 nt
    s_waitcnt vmcnt(3)
    buffer_load_dwordx4 v[236:239], v1, s[8:11], s53 offen offset:2176 nt
    s_waitcnt vmcnt(3)
    buffer_load_dwordx4 v[240:243], v1, s[8:11], s54 offen offset:0 nt
    buffer_load_dwordx4 v[244:247], v1, s[8:11], s54 offen offset:128 nt
    buffer_load_dwordx4 v[248:251], v1, s[8:11], s54 offen offset:2048 nt
    s_waitcnt vmcnt(5)
    buffer_load_dwordx4 v[252:255], v1, s[8:11], s54 offen offset:2176 nt
    v_add_f32 v32, v32, v36
    v_add_f32 v40, v40, v44
    v_add_f32 v33, v33, v37
    v_add_f32 v41, v41, v45
    v_add_f32 v34, v34, v38
    v_add_f32 v42, v42, v46
    v_add_f32 v35, v35, v39
    v_add_f32 v43, v43, v47
    v_add_f32 v32, v32, v40
    v_add_f32 v33, v33, v41
    v_add_f32 v34, v34, v42
    v_add_f32 v35, v35, v43
    v_mov_b32 v36, v32
    v_mov_b32 v37, v33
    v_mov_b32 v38, v34
    v_mov_b32 v39, v35
    v_permlane32_swap_b32 v32, v36
    v_permlane32_swap_b32 v33, v37
    v_permlane32_swap_b32 v34, v38
    v_permlane32_swap_b32 v35, v39
    v_add_f32 v32, v32, v36
    v_add_f32 v33, v33, v37
    v_add_f32 v34, v34, v38
    v_add_f32 v35, v35, v39
    v_cvt_pk_bf16_f32 v36, v32, v33
    v_cvt_pk_bf16_f32 v37, v34, v35
    s_mul_i32 s69, s3, 272
    v_add_u32 v10, s69, v8
    s_mov_b32 exec_hi, 0
    ds_write_b64 v10, v[36:37] offset:20480
    s_mov_b32 exec_hi, -1
    s_waitcnt lgkmcnt(0)
    s_barrier
    v_and_b32 v10, 7, v0
    v_mul_u32_u24 v10, 272, v10
    v_bfe_u32 v11, v0, 3, 1
    v_lshl_add_u32 v10, v11, 6, v10
    v_lshl_add_u32 v10, v5, 4, v10
    ds_read_b128 v[24:27], v10 offset:20480
    ds_read_b128 v[28:31], v10 offset:20608
    s_cmp_eq_u32 s3, 1
    s_cbranch_scc0 L_role_8
    v_and_b32 v10, 31, v0
    v_lshlrev_b32 v10, 4, v10
    v_lshrrev_b32 v11, 5, v0
    v_lshl_add_u32 v11, v11, 12, v10
    ds_read_b128 v[32:35], v11 offset:4096
    ds_read_b128 v[36:39], v11 offset:4608
    ds_read_b128 v[40:43], v11 offset:5120
    ds_read_b128 v[44:47], v11 offset:5632
    ds_read_b128 v[48:51], v11 offset:6144
    ds_read_b128 v[52:55], v11 offset:6656
    ds_read_b128 v[56:59], v11 offset:7168
    ds_read_b128 v[60:63], v11 offset:7680
    v_mov_b32 v11, s72
    v_mov_b32 v12, s1
    v_cmp_gt_u32 vcc, 32, v0
    s_nop 1
    v_cndmask_b32 v11, v12, v11, vcc
    v_add_u32 v10, v10, v11
    s_waitcnt lgkmcnt(0)
    v_add_f32 v32, v32, v36
    v_add_f32 v33, v33, v37
    v_add_f32 v34, v34, v38
    v_add_f32 v35, v35, v39
    v_add_f32 v40, v40, v44
    v_add_f32 v41, v41, v45
    v_add_f32 v42, v42, v46
    v_add_f32 v43, v43, v47
    v_add_f32 v48, v48, v52
    v_add_f32 v49, v49, v53
    v_add_f32 v50, v50, v54
    v_add_f32 v51, v51, v55
    v_add_f32 v56, v56, v60
    v_add_f32 v57, v57, v61
    v_add_f32 v58, v58, v62
    v_add_f32 v59, v59, v63
    v_add_f32 v32, v32, v40
    v_add_f32 v33, v33, v41
    v_add_f32 v34, v34, v42
    v_add_f32 v35, v35, v43
    v_add_f32 v48, v48, v56
    v_add_f32 v49, v49, v57
    v_add_f32 v50, v50, v58
    v_add_f32 v51, v51, v59
    v_add_f32 v32, v32, v48
    v_add_f32 v33, v33, v49
    v_add_f32 v34, v34, v50
    v_add_f32 v35, v35, v51
    buffer_store_dwordx4 v[32:35], v10, s[36:39], 0 offen sc1
L_role_8:
    s_waitcnt lgkmcnt(0)
    v_mfma_f32_16x16x32_bf16 v[64:67], v[128:131], v[24:27], 0
    v_mfma_f32_16x16x32_bf16 v[68:71], v[136:139], v[24:27], 0
    v_mfma_f32_16x16x32_bf16 v[64:67], v[132:135], v[28:31], v[64:67]
    v_mfma_f32_16x16x32_bf16 v[68:71], v[140:143], v[28:31], v[68:71]
    s_lshl_b32 s69, s65, 18
    s_lshl_b32 s70, s3, 15
    s_add_u32 s69, s69, s70
    s_xor_b32 s70, s68, 1
    s_lshl_b32 s70, s70, 8
    s_add_u32 s69, s69, s70
    v_lshlrev_b32 v3, 13, v5
    v_lshl_add_u32 v3, v6, 4, v3
    v_add_u32 v3, s69, v3
    s_movk_i32 s73, 4096
    s_lshr_b32 s69, s65, 2
    s_lshl_b32 s69, s69, 20
    s_and_b32 s70, s65, 3
    s_lshl_b32 s70, s70, 16
    s_add_u32 s69, s69, s70
    s_lshl_b32 s70, s3, 13
    s_add_u32 s69, s69, s70
    s_lshl_b32 s70, s68, 8
    s_add_u32 s69, s69, s70
    v_lshlrev_b32 v4, 11, v5
    v_lshl_add_u32 v4, v6, 4, v4
    v_add_u32 v4, s69, v4
    s_mov_b32 s74, 262144
    s_mov_b32 s75, 524288
    s_mov_b32 s72, 786432
    s_waitcnt vmcnt(4)
    buffer_load_dwordx4 v[128:131], v2, s[12:15], 0 offen offset:0 nt
    v_mfma_f32_16x16x32_bf16 v[72:75], v[144:147], v[24:27], 0
    v_mfma_f32_16x16x32_bf16 v[76:79], v[152:155], v[24:27], 0
    v_mfma_f32_16x16x32_bf16 v[72:75], v[148:151], v[28:31], v[72:75]
    v_mfma_f32_16x16x32_bf16 v[76:79], v[156:159], v[28:31], v[76:79]
    v_permlane32_swap_b32 v64, v68
    v_permlane32_swap_b32 v65, v69
    v_permlane32_swap_b32 v66, v70
    v_permlane32_swap_b32 v67, v71
    v_add_f32_dpp v32, v68, v64 row_ror:8 row_mask:0xf bank_mask:0xf
    v_add_f32_dpp v33, v69, v65 row_ror:8 row_mask:0xf bank_mask:0xf
    v_add_f32_dpp v34, v70, v66 row_ror:8 row_mask:0xf bank_mask:0xf
    v_add_f32_dpp v35, v71, v67 row_ror:8 row_mask:0xf bank_mask:0xf
    v_permlane16_swap_b32 v32, v33
    s_nop 0
    v_permlane16_swap_b32 v34, v35
    s_nop 1
    v_permlane32_swap_b32 v32, v34
    v_permlane32_swap_b32 v33, v35
    v_cvt_pk_bf16_f32 v64, v32, v33
    v_cvt_pk_bf16_f32 v66, v34, v35
    v_lshlrev_b32 v32, 16, v64
    v_and_b32 v33, s55, v64
    v_lshlrev_b32 v34, 16, v66
    v_and_b32 v35, s55, v66
    v_mul_f32 v32, s56, v32
    v_mul_f32 v33, s56, v33
    v_mul_f32 v34, s56, v34
    v_mul_f32 v35, s56, v35
    v_cvt_pk_bf16_f32 v64, v32, v33
    v_cvt_pk_bf16_f32 v66, v34, v35
    v_lshlrev_b32 v32, 16, v64
    v_and_b32 v33, s55, v64
    v_lshlrev_b32 v34, 16, v66
    v_and_b32 v35, s55, v66
    s_waitcnt vmcnt(4)
    buffer_load_dwordx4 v[132:135], v2, s[12:15], 0 offen offset:1024 nt
    v_mfma_f32_16x16x32_bf16 v[64:67], v[160:163], v[24:27], 0
    v_mfma_f32_16x16x32_bf16 v[68:71], v[168:171], v[24:27], 0
    v_mfma_f32_16x16x32_bf16 v[64:67], v[164:167], v[28:31], v[64:67]
    v_mfma_f32_16x16x32_bf16 v[68:71], v[172:175], v[28:31], v[68:71]
    v_permlane32_swap_b32 v72, v76
    v_permlane32_swap_b32 v73, v77
    v_permlane32_swap_b32 v74, v78
    v_permlane32_swap_b32 v75, v79
    v_add_f32_dpp v36, v76, v72 row_ror:8 row_mask:0xf bank_mask:0xf
    v_add_f32_dpp v37, v77, v73 row_ror:8 row_mask:0xf bank_mask:0xf
    v_add_f32_dpp v38, v78, v74 row_ror:8 row_mask:0xf bank_mask:0xf
    v_add_f32_dpp v39, v79, v75 row_ror:8 row_mask:0xf bank_mask:0xf
    v_permlane16_swap_b32 v36, v37
    s_nop 0
    v_permlane16_swap_b32 v38, v39
    s_nop 1
    v_permlane32_swap_b32 v36, v38
    v_permlane32_swap_b32 v37, v39
    v_cvt_pk_bf16_f32 v72, v36, v37
    v_cvt_pk_bf16_f32 v74, v38, v39
    v_lshlrev_b32 v36, 16, v72
    v_and_b32 v37, s55, v72
    v_lshlrev_b32 v38, 16, v74
    v_and_b32 v39, s55, v74
    v_mul_f32 v36, s56, v36
    v_mul_f32 v37, s56, v37
    v_mul_f32 v38, s56, v38
    v_mul_f32 v39, s56, v39
    v_cvt_pk_bf16_f32 v72, v36, v37
    v_cvt_pk_bf16_f32 v74, v38, v39
    v_lshlrev_b32 v36, 16, v72
    v_and_b32 v37, s55, v72
    v_lshlrev_b32 v38, 16, v74
    v_and_b32 v39, s55, v74
    s_waitcnt vmcnt(4)
    buffer_load_dwordx4 v[136:139], v2, s[12:15], 0 offen offset:2048 nt
    v_mfma_f32_16x16x32_bf16 v[72:75], v[176:179], v[24:27], 0
    v_mfma_f32_16x16x32_bf16 v[76:79], v[184:187], v[24:27], 0
    v_mfma_f32_16x16x32_bf16 v[72:75], v[180:183], v[28:31], v[72:75]
    v_mfma_f32_16x16x32_bf16 v[76:79], v[188:191], v[28:31], v[76:79]
    v_permlane32_swap_b32 v64, v68
    v_permlane32_swap_b32 v65, v69
    v_permlane32_swap_b32 v66, v70
    v_permlane32_swap_b32 v67, v71
    v_add_f32_dpp v40, v68, v64 row_ror:8 row_mask:0xf bank_mask:0xf
    v_add_f32_dpp v41, v69, v65 row_ror:8 row_mask:0xf bank_mask:0xf
    v_add_f32_dpp v42, v70, v66 row_ror:8 row_mask:0xf bank_mask:0xf
    v_add_f32_dpp v43, v71, v67 row_ror:8 row_mask:0xf bank_mask:0xf
    v_permlane16_swap_b32 v40, v41
    s_nop 0
    v_permlane16_swap_b32 v42, v43
    s_nop 1
    v_permlane32_swap_b32 v40, v42
    v_permlane32_swap_b32 v41, v43
    v_cvt_pk_bf16_f32 v64, v40, v41
    v_cvt_pk_bf16_f32 v66, v42, v43
    v_lshlrev_b32 v40, 16, v64
    v_and_b32 v41, s55, v64
    v_lshlrev_b32 v42, 16, v66
    v_and_b32 v43, s55, v66
    v_mul_f32 v40, s56, v40
    v_mul_f32 v41, s56, v41
    v_mul_f32 v42, s56, v42
    v_mul_f32 v43, s56, v43
    v_cvt_pk_bf16_f32 v64, v40, v41
    v_cvt_pk_bf16_f32 v66, v42, v43
    v_lshlrev_b32 v40, 16, v64
    v_and_b32 v41, s55, v64
    v_lshlrev_b32 v42, 16, v66
    v_and_b32 v43, s55, v66
    s_waitcnt vmcnt(4)
    buffer_load_dwordx4 v[140:143], v2, s[12:15], 0 offen offset:3072 nt
    v_mfma_f32_16x16x32_bf16 v[64:67], v[192:195], v[24:27], 0
    v_mfma_f32_16x16x32_bf16 v[68:71], v[200:203], v[24:27], 0
    v_mfma_f32_16x16x32_bf16 v[64:67], v[196:199], v[28:31], v[64:67]
    v_mfma_f32_16x16x32_bf16 v[68:71], v[204:207], v[28:31], v[68:71]
    v_permlane32_swap_b32 v72, v76
    v_permlane32_swap_b32 v73, v77
    v_permlane32_swap_b32 v74, v78
    v_permlane32_swap_b32 v75, v79
    v_add_f32_dpp v44, v76, v72 row_ror:8 row_mask:0xf bank_mask:0xf
    v_add_f32_dpp v45, v77, v73 row_ror:8 row_mask:0xf bank_mask:0xf
    v_add_f32_dpp v46, v78, v74 row_ror:8 row_mask:0xf bank_mask:0xf
    v_add_f32_dpp v47, v79, v75 row_ror:8 row_mask:0xf bank_mask:0xf
    v_permlane16_swap_b32 v44, v45
    s_nop 0
    v_permlane16_swap_b32 v46, v47
    s_nop 1
    v_permlane32_swap_b32 v44, v46
    v_permlane32_swap_b32 v45, v47
    v_cvt_pk_bf16_f32 v72, v44, v45
    v_cvt_pk_bf16_f32 v74, v46, v47
    v_lshlrev_b32 v44, 16, v72
    v_and_b32 v45, s55, v72
    v_lshlrev_b32 v46, 16, v74
    v_and_b32 v47, s55, v74
    v_mul_f32 v44, s56, v44
    v_mul_f32 v45, s56, v45
    v_mul_f32 v46, s56, v46
    v_mul_f32 v47, s56, v47
    v_cvt_pk_bf16_f32 v72, v44, v45
    v_cvt_pk_bf16_f32 v74, v46, v47
    v_lshlrev_b32 v44, 16, v72
    v_and_b32 v45, s55, v72
    v_lshlrev_b32 v46, 16, v74
    v_and_b32 v47, s55, v74
    s_cmp_eq_u32 s3, 1
    s_cbranch_scc0 L_role_9
    s_waitcnt vmcnt(4)
    s_lshl_b32 s69, s67, 10
    s_add_u32 s69, s69, 462848
    v_lshl_add_u32 v10, v0, 7, s69
    v_mov_b32 v11, 1
    s_mov_b64 exec, 0xff
    buffer_atomic_add v11, v10, s[36:39], 0 offen
    s_mov_b64 exec, -1
L_role_9:
    s_waitcnt vmcnt(4)
    buffer_load_dwordx4 v[144:147], v2, s[12:15], s48 offen offset:0 nt
    v_mfma_f32_16x16x32_bf16 v[72:75], v[208:211], v[24:27], 0
    v_mfma_f32_16x16x32_bf16 v[76:79], v[216:219], v[24:27], 0
    v_mfma_f32_16x16x32_bf16 v[72:75], v[212:215], v[28:31], v[72:75]
    v_mfma_f32_16x16x32_bf16 v[76:79], v[220:223], v[28:31], v[76:79]
    v_permlane32_swap_b32 v64, v68
    v_permlane32_swap_b32 v65, v69
    v_permlane32_swap_b32 v66, v70
    v_permlane32_swap_b32 v67, v71
    v_add_f32_dpp v48, v68, v64 row_ror:8 row_mask:0xf bank_mask:0xf
    v_add_f32_dpp v49, v69, v65 row_ror:8 row_mask:0xf bank_mask:0xf
    v_add_f32_dpp v50, v70, v66 row_ror:8 row_mask:0xf bank_mask:0xf
    v_add_f32_dpp v51, v71, v67 row_ror:8 row_mask:0xf bank_mask:0xf
    v_permlane16_swap_b32 v48, v49
    s_nop 0
    v_permlane16_swap_b32 v50, v51
    s_nop 1
    v_permlane32_swap_b32 v48, v50
    v_permlane32_swap_b32 v49, v51
    v_cvt_pk_bf16_f32 v64, v48, v49
    v_cvt_pk_bf16_f32 v66, v50, v51
    v_lshlrev_b32 v48, 16, v64
    v_and_b32 v49, s55, v64
    v_lshlrev_b32 v50, 16, v66
    v_and_b32 v51, s55, v66
    v_mul_f32 v48, s56, v48
    v_mul_f32 v49, s56, v49
    v_mul_f32 v50, s56, v50
    v_mul_f32 v51, s56, v51
    v_cvt_pk_bf16_f32 v64, v48, v49
    v_cvt_pk_bf16_f32 v66, v50, v51
    v_lshlrev_b32 v48, 16, v64
    v_and_b32 v49, s55, v64
    v_lshlrev_b32 v50, 16, v66
    v_and_b32 v51, s55, v66
    s_waitcnt vmcnt(4)
    buffer_load_dwordx4 v[148:151], v2, s[12:15], s48 offen offset:1024 nt
    v_mfma_f32_16x16x32_bf16 v[64:67], v[224:227], v[24:27], 0
    v_mfma_f32_16x16x32_bf16 v[68:71], v[232:235], v[24:27], 0
    v_mfma_f32_16x16x32_bf16 v[64:67], v[228:231], v[28:31], v[64:67]
    v_mfma_f32_16x16x32_bf16 v[68:71], v[236:239], v[28:31], v[68:71]
    v_permlane32_swap_b32 v72, v76
    v_permlane32_swap_b32 v73, v77
    v_permlane32_swap_b32 v74, v78
    v_permlane32_swap_b32 v75, v79
    v_add_f32_dpp v52, v76, v72 row_ror:8 row_mask:0xf bank_mask:0xf
    v_add_f32_dpp v53, v77, v73 row_ror:8 row_mask:0xf bank_mask:0xf
    v_add_f32_dpp v54, v78, v74 row_ror:8 row_mask:0xf bank_mask:0xf
    v_add_f32_dpp v55, v79, v75 row_ror:8 row_mask:0xf bank_mask:0xf
    v_permlane16_swap_b32 v52, v53
    s_nop 0
    v_permlane16_swap_b32 v54, v55
    s_nop 1
    v_permlane32_swap_b32 v52, v54
    v_permlane32_swap_b32 v53, v55
    v_cvt_pk_bf16_f32 v72, v52, v53
    v_cvt_pk_bf16_f32 v74, v54, v55
    v_lshlrev_b32 v52, 16, v72
    v_and_b32 v53, s55, v72
    v_lshlrev_b32 v54, 16, v74
    v_and_b32 v55, s55, v74
    v_mul_f32 v52, s56, v52
    v_mul_f32 v53, s56, v53
    v_mul_f32 v54, s56, v54
    v_mul_f32 v55, s56, v55
    v_cvt_pk_bf16_f32 v72, v52, v53
    v_cvt_pk_bf16_f32 v74, v54, v55
    v_lshlrev_b32 v52, 16, v72
    v_and_b32 v53, s55, v72
    v_lshlrev_b32 v54, 16, v74
    v_and_b32 v55, s55, v74
    s_waitcnt vmcnt(4)
    buffer_load_dwordx4 v[152:155], v2, s[12:15], s48 offen offset:2048 nt
    v_mfma_f32_16x16x32_bf16 v[72:75], v[240:243], v[24:27], 0
    v_mfma_f32_16x16x32_bf16 v[76:79], v[248:251], v[24:27], 0
    v_mfma_f32_16x16x32_bf16 v[72:75], v[244:247], v[28:31], v[72:75]
    v_mfma_f32_16x16x32_bf16 v[76:79], v[252:255], v[28:31], v[76:79]
    v_permlane32_swap_b32 v64, v68
    v_permlane32_swap_b32 v65, v69
    v_permlane32_swap_b32 v66, v70
    v_permlane32_swap_b32 v67, v71
    v_add_f32_dpp v56, v68, v64 row_ror:8 row_mask:0xf bank_mask:0xf
    v_add_f32_dpp v57, v69, v65 row_ror:8 row_mask:0xf bank_mask:0xf
    v_add_f32_dpp v58, v70, v66 row_ror:8 row_mask:0xf bank_mask:0xf
    v_add_f32_dpp v59, v71, v67 row_ror:8 row_mask:0xf bank_mask:0xf
    v_permlane16_swap_b32 v56, v57
    s_nop 0
    v_permlane16_swap_b32 v58, v59
    s_nop 1
    v_permlane32_swap_b32 v56, v58
    v_permlane32_swap_b32 v57, v59
    v_cvt_pk_bf16_f32 v64, v56, v57
    v_cvt_pk_bf16_f32 v66, v58, v59
    v_lshlrev_b32 v56, 16, v64
    v_and_b32 v57, s55, v64
    v_lshlrev_b32 v58, 16, v66
    v_and_b32 v59, s55, v66
    v_mul_f32 v56, s56, v56
    v_mul_f32 v57, s56, v57
    v_mul_f32 v58, s56, v58
    v_mul_f32 v59, s56, v59
    v_cvt_pk_bf16_f32 v64, v56, v57
    v_cvt_pk_bf16_f32 v66, v58, v59
    v_lshlrev_b32 v56, 16, v64
    v_and_b32 v57, s55, v64
    v_lshlrev_b32 v58, 16, v66
    v_and_b32 v59, s55, v66
    s_waitcnt vmcnt(4)
    buffer_load_dwordx4 v[156:159], v2, s[12:15], s48 offen offset:3072 nt
    v_permlane32_swap_b32 v72, v76
    v_permlane32_swap_b32 v73, v77
    v_permlane32_swap_b32 v74, v78
    v_permlane32_swap_b32 v75, v79
    v_add_f32_dpp v60, v76, v72 row_ror:8 row_mask:0xf bank_mask:0xf
    v_add_f32_dpp v61, v77, v73 row_ror:8 row_mask:0xf bank_mask:0xf
    v_add_f32_dpp v62, v78, v74 row_ror:8 row_mask:0xf bank_mask:0xf
    v_add_f32_dpp v63, v79, v75 row_ror:8 row_mask:0xf bank_mask:0xf
    v_permlane16_swap_b32 v60, v61
    s_nop 0
    v_permlane16_swap_b32 v62, v63
    s_nop 1
    v_permlane32_swap_b32 v60, v62
    v_permlane32_swap_b32 v61, v63
    v_cvt_pk_bf16_f32 v72, v60, v61
    v_cvt_pk_bf16_f32 v74, v62, v63
    v_lshlrev_b32 v60, 16, v72
    v_and_b32 v61, s55, v72
    v_lshlrev_b32 v62, 16, v74
    v_and_b32 v63, s55, v74
    v_mul_f32 v60, s56, v60
    v_mul_f32 v61, s56, v61
    v_mul_f32 v62, s56, v62
    v_mul_f32 v63, s56, v63
    v_cvt_pk_bf16_f32 v72, v60, v61
    v_cvt_pk_bf16_f32 v74, v62, v63
    v_lshlrev_b32 v60, 16, v72
    v_and_b32 v61, s55, v72
    v_lshlrev_b32 v62, 16, v74
    v_and_b32 v63, s55, v74
    v_max3_f32 v10, v32, v33, v34
    v_max3_f32 v10, v10, v35, v36
    v_max3_f32 v10, v10, v37, v38
    v_max3_f32 v10, v10, v39, v40
    v_max3_f32 v10, v10, v41, v42
    v_max3_f32 v10, v10, v43, v44
    v_max3_f32 v10, v10, v45, v46
    v_max3_f32 v10, v10, v47, v48
    v_max3_f32 v10, v10, v49, v50
    v_max3_f32 v10, v10, v51, v52
    v_max3_f32 v10, v10, v53, v54
    v_max3_f32 v10, v10, v55, v56
    v_max3_f32 v10, v10, v57, v58
    v_max3_f32 v10, v10, v59, v60
    v_max3_f32 v10, v10, v61, v62
    v_max_f32 v10, v10, v63
    v_mov_b32 v14, v10
    s_nop 1
    v_permlane16_swap_b32 v10, v14
    v_max_f32 v10, v10, v14
    v_mov_b32 v14, v10
    s_nop 1
    v_permlane32_swap_b32 v10, v14
    v_max_f32 v10, v10, v14
    s_lshl_b32 s69, s3, 2
    v_lshl_add_u32 v14, v6, 5, s69
    ds_write_b32 v14, v10 offset:22784
    s_waitcnt lgkmcnt(0)
    s_barrier
    v_and_b32 v15, 7, v0
    v_lshlrev_b32 v15, 5, v15
    ds_read_b128 v[24:27], v15 offset:22784
    ds_read_b128 v[28:31], v15 offset:22800
    s_waitcnt lgkmcnt(0)
    v_max3_f32 v10, v24, v25, v26
    v_max3_f32 v10, v10, v27, v28
    v_max3_f32 v10, v10, v29, v30
    v_max_f32 v10, v10, v31
    v_mul_f32 v10, s59, v10
    v_cmp_gt_u32 vcc, 8, v6
    v_sub_f32 v11, 0, v10
    v_mov_b32 v12, s59
    v_mov_b32 v15, 0xf149f2ca
    v_cndmask_b32 v11, v15, v11, vcc
    v_cndmask_b32 v12, 0, v12, vcc
    s_waitcnt vmcnt(4)
    buffer_load_dwordx4 v[160:163], v2, s[12:15], s49 offen offset:0 nt
    v_fma_f32 v32, v32, v12, v11
    v_fma_f32 v33, v33, v12, v11
    v_fma_f32 v34, v34, v12, v11
    v_fma_f32 v35, v35, v12, v11
    v_fma_f32 v36, v36, v12, v11
    v_fma_f32 v37, v37, v12, v11
    v_fma_f32 v38, v38, v12, v11
    v_fma_f32 v39, v39, v12, v11
    v_exp_f32 v32, v32
    v_exp_f32 v33, v33
    v_exp_f32 v34, v34
    v_exp_f32 v35, v35
    v_exp_f32 v36, v36
    v_exp_f32 v37, v37
    v_exp_f32 v38, v38
    v_exp_f32 v39, v39
    v_cvt_pk_bf16_f32 v64, v32, v33
    v_cvt_pk_bf16_f32 v65, v34, v35
    v_cvt_pk_bf16_f32 v66, v36, v37
    v_cvt_pk_bf16_f32 v67, v38, v39
    s_cmp_eq_u32 s3, 7
    s_cbranch_scc0 L_role_10
    v_bfe_u32 v14, v0, 2, 1
    v_lshlrev_b32 v14, 10, v14
    v_and_b32 v15, 3, v0
    v_lshl_add_u32 v14, v15, 2, v14
    v_add_u32 v14, s76, v14
    v_min_u32 v15, -2, v10
    s_mov_b64 exec, 0xff
    buffer_store_dword v15, v14, s[36:39], 0 offen sc1
    s_mov_b64 exec, -1
L_role_10:
    s_waitcnt vmcnt(4)
    buffer_load_dwordx4 v[164:167], v2, s[12:15], s49 offen offset:1024 nt
    v_fma_f32 v40, v40, v12, v11
    v_fma_f32 v41, v41, v12, v11
    v_fma_f32 v42, v42, v12, v11
    v_fma_f32 v43, v43, v12, v11
    v_fma_f32 v44, v44, v12, v11
    v_fma_f32 v45, v45, v12, v11
    v_fma_f32 v46, v46, v12, v11
    v_fma_f32 v47, v47, v12, v11
    v_exp_f32 v40, v40
    v_exp_f32 v41, v41
    v_exp_f32 v42, v42
    v_exp_f32 v43, v43
    v_exp_f32 v44, v44
    v_exp_f32 v45, v45
    v_exp_f32 v46, v46
    v_exp_f32 v47, v47
    v_cvt_pk_bf16_f32 v68, v40, v41
    v_cvt_pk_bf16_f32 v69, v42, v43
    v_cvt_pk_bf16_f32 v70, v44, v45
    v_cvt_pk_bf16_f32 v71, v46, v47
    s_mul_i32 s69, s3, 4352
    v_mul_u32_u24 v24, 272, v6
    v_lshl_add_u32 v24, v5, 4, v24
    v_add_u32 v24, s69, v24
    s_mul_i32 s69, s3, 1088
    v_bfe_u32 v25, v0, 3, 2
    v_mul_u32_u24 v25, 272, v25
    v_and_b32 v30, 7, v0
    v_lshl_add_u32 v25, v30, 5, v25
    v_lshrrev_b32 v14, 5, v0
    v_lshl_add_u32 v25, v14, 4, v25
    v_add_u32 v25, s69, v25
    v_and_b32 v26, 1, v0
    v_lshlrev_b32 v26, 2, v26
    v_and_b32 v31, 2, v0
    v_add3_u32 v31, v31, v26, s79
    v_and_b32 v26, 3, v0
    v_lshlrev_b32 v26, 4, v26
    v_bfe_u32 v27, v0, 2, 3
    v_lshl_add_u32 v26, v27, 12, v26
    v_lshl_add_u32 v26, v14, 17, v26
    s_lshl_b32 s69, s3, 15
    s_add_u32 s69, s69, s77
    v_add_u32 v26, s69, v26
    s_lshr_b32 s71, s65, 2
    s_lshl_b32 s69, s71, 17
    s_and_b32 s70, s65, 3
    s_lshl_b32 s70, s70, 15
    s_add_u32 s69, s69, s70
    s_lshl_b32 s70, s3, 12
    s_add_u32 s69, s69, s70
    s_add_u32 s69, s69, 1048576
    v_lshlrev_b32 v27, 6, v6
    v_lshl_add_u32 v27, v5, 4, v27
    v_add_u32 v27, s69, v27
    s_lshl_b32 s69, s71, 10
    s_add_u32 s69, s69, 393216
    v_lshl_add_u32 v28, v0, 4, s69
    v_mov_b32 v29, s78
    v_mov_b32 v30, s0
    v_cmp_gt_u32 vcc, 32, v0
    s_nop 1
    v_cndmask_b32 v29, v30, v29, vcc
    v_and_b32 v30, 31, v0
    v_lshl_add_u32 v29, v30, 4, v29
    s_lshl_b32 s69, s66, 14
    s_and_b32 s70, s79, 255
    s_lshl_b32 s70, s70, 1
    s_add_u32 s69, s69, s70
    s_add_u32 s69, s69, 524288
    v_lshlrev_b32 v30, 9, v30
    v_lshl_add_u32 v30, v14, 17, v30
    v_add_u32 v30, s69, v30
    s_waitcnt vmcnt(4)
    buffer_load_dwordx4 v[168:171], v2, s[12:15], s49 offen offset:2048 nt
    v_fma_f32 v48, v48, v12, v11
    v_fma_f32 v49, v49, v12, v11
    v_fma_f32 v50, v50, v12, v11
    v_fma_f32 v51, v51, v12, v11
    v_fma_f32 v52, v52, v12, v11
    v_fma_f32 v53, v53, v12, v11
    v_fma_f32 v54, v54, v12, v11
    v_fma_f32 v55, v55, v12, v11
    v_exp_f32 v48, v48
    v_exp_f32 v49, v49
    v_exp_f32 v50, v50
    v_exp_f32 v51, v51
    v_exp_f32 v52, v52
    v_exp_f32 v53, v53
    v_exp_f32 v54, v54
    v_exp_f32 v55, v55
    v_cvt_pk_bf16_f32 v72, v48, v49
    v_cvt_pk_bf16_f32 v73, v50, v51
    v_cvt_pk_bf16_f32 v74, v52, v53
    v_cvt_pk_bf16_f32 v75, v54, v55
    s_waitcnt vmcnt(4)
    buffer_load_dwordx4 v[172:175], v2, s[12:15], s49 offen offset:3072 nt
    v_fma_f32 v56, v56, v12, v11
    v_fma_f32 v57, v57, v12, v11
    v_fma_f32 v58, v58, v12, v11
    v_fma_f32 v59, v59, v12, v11
    v_fma_f32 v60, v60, v12, v11
    v_fma_f32 v61, v61, v12, v11
    v_fma_f32 v62, v62, v12, v11
    v_fma_f32 v63, v63, v12, v11
    v_exp_f32 v56, v56
    v_exp_f32 v57, v57
    v_exp_f32 v58, v58
    v_exp_f32 v59, v59
    v_exp_f32 v60, v60
    v_exp_f32 v61, v61
    v_exp_f32 v62, v62
    v_exp_f32 v63, v63
    v_cvt_pk_bf16_f32 v76, v56, v57
    v_cvt_pk_bf16_f32 v77, v58, v59
    v_cvt_pk_bf16_f32 v78, v60, v61
    v_cvt_pk_bf16_f32 v79, v62, v63
    v_mov_b32 v112, 0x3f803f80
    v_mov_b32 v113, 0x3f803f80
    v_mov_b32 v114, 0x3f803f80
    v_mov_b32 v115, 0x3f803f80
    s_nop 1
    v_mfma_f32_16x16x32_bf16 v[12:15], v[64:67], v[112:115], 0
    v_mfma_f32_16x16x32_bf16 v[12:15], v[68:71], v[112:115], v[12:15]
    v_mfma_f32_16x16x32_bf16 v[12:15], v[72:75], v[112:115], v[12:15]
    v_mfma_f32_16x16x32_bf16 v[12:15], v[76:79], v[112:115], v[12:15]
    s_mov_b32 exec_hi, 0
    s_nop 6
    ds_write_b128 v7, v[12:15] offset:0
    s_mov_b32 exec_hi, -1
    s_waitcnt lgkmcnt(0)
    v_mov_b32 v10, 0
    v_mov_b32 v11, 1
    s_mov_b64 exec, 1
    ds_add_u32 v10, v11 offset:23808
    s_mov_b64 exec, -1
    s_waitcnt vmcnt(4)
    buffer_load_dwordx4 v[176:179], v2, s[12:15], s50 offen offset:0 nt
    v_perm_b32 v112, v132, v128, s57
    v_perm_b32 v113, v140, v136, s57
    v_perm_b32 v114, v148, v144, s57
    v_perm_b32 v115, v156, v152, s57
    v_perm_b32 v116, v132, v128, s58
    v_perm_b32 v117, v140, v136, s58
    v_perm_b32 v118, v148, v144, s58
    v_perm_b32 v119, v156, v152, s58
    v_mfma_f32_16x16x32_bf16 v[32:35], v[64:67], v[112:115], 0
    v_perm_b32 v112, v133, v129, s57
    v_perm_b32 v113, v141, v137, s57
    v_perm_b32 v114, v149, v145, s57
    v_perm_b32 v115, v157, v153, s57
    v_mfma_f32_16x16x32_bf16 v[36:39], v[64:67], v[116:119], 0
    v_perm_b32 v116, v133, v129, s58
    v_perm_b32 v117, v141, v137, s58
    v_perm_b32 v118, v149, v145, s58
    v_perm_b32 v119, v157, v153, s58
    v_mfma_f32_16x16x32_bf16 v[40:43], v[64:67], v[112:115], 0
    v_perm_b32 v112, v134, v130, s57
    v_perm_b32 v113, v142, v138, s57
    v_perm_b32 v114, v150, v146, s57
    v_perm_b32 v115, v158, v154, s57
    v_mfma_f32_16x16x32_bf16 v[44:47], v[64:67], v[116:119], 0
    v_perm_b32 v116, v134, v130, s58
    v_perm_b32 v117, v142, v138, s58
    v_perm_b32 v118, v150, v146, s58
    v_perm_b32 v119, v158, v154, s58
    v_mfma_f32_16x16x32_bf16 v[48:51], v[64:67], v[112:115], 0
    v_perm_b32 v112, v135, v131, s57
    v_perm_b32 v113, v143, v139, s57
    v_perm_b32 v114, v151, v147, s57
    v_perm_b32 v115, v159, v155, s57
    v_mfma_f32_16x16x32_bf16 v[52:55], v[64:67], v[116:119], 0
    v_perm_b32 v116, v135, v131, s58
    v_perm_b32 v117, v143, v139, s58
    v_perm_b32 v118, v151, v147, s58
    v_perm_b32 v119, v159, v155, s58
    v_mfma_f32_16x16x32_bf16 v[56:59], v[64:67], v[112:115], 0
    s_nop 0
    v_mfma_f32_16x16x32_bf16 v[60:63], v[64:67], v[116:119], 0
    s_waitcnt vmcnt(4)
    buffer_load_dwordx4 v[180:183], v2, s[12:15], s50 offen offset:1024 nt
    s_cmp_eq_u32 s3, 7
    s_cbranch_scc0 L_role_11
    v_mov_b32 v10, 0
L_lw_12:
    ds_read_b32 v11, v10 offset:23808
    s_waitcnt lgkmcnt(0)
    v_readfirstlane_b32 s69, v11
    s_nop 0
    s_cmp_lt_u32 s69, 8
    s_cbranch_scc1 L_lw_12
    v_lshlrev_b32 v10, 4, v0
    s_mov_b64 exec, 3
    ds_read_b128 v[128:131], v10 offset:0
    ds_read_b128 v[132:135], v10 offset:512
    ds_read_b128 v[136:139], v10 offset:1024
    ds_read_b128 v[140:143], v10 offset:1536
    ds_read_b128 v[144:147], v10 offset:2048
    ds_read_b128 v[148:151], v10 offset:2560
    ds_read_b128 v[152:155], v10 offset:3072
    ds_read_b128 v[156:159], v10 offset:3584
    v_lshlrev_b32 v11, 10, v0
    v_add_u32 v11, s76, v11
    v_add_u32 v11, 8192, v11
    s_waitcnt lgkmcnt(0)
    v_add_f32 v128, v128, v132
    v_add_f32 v129, v129, v133
    v_add_f32 v130, v130, v134
    v_add_f32 v131, v131, v135
    v_add_f32 v136, v136, v140
    v_add_f32 v137, v137, v141
    v_add_f32 v138, v138, v142
    v_add_f32 v139, v139, v143
    v_add_f32 v144, v144, v148
    v_add_f32 v145, v145, v149
    v_add_f32 v146, v146, v150
    v_add_f32 v147, v147, v151
    v_add_f32 v152, v152, v156
    v_add_f32 v153, v153, v157
    v_add_f32 v154, v154, v158
    v_add_f32 v155, v155, v159
    v_add_f32 v128, v128, v136
    v_add_f32 v129, v129, v137
    v_add_f32 v130, v130, v138
    v_add_f32 v131, v131, v139
    v_add_f32 v144, v144, v152
    v_add_f32 v145, v145, v153
    v_add_f32 v146, v146, v154
    v_add_f32 v147, v147, v155
    v_add_f32 v128, v128, v144
    v_add_f32 v129, v129, v145
    v_add_f32 v130, v130, v146
    v_add_f32 v131, v131, v147
    v_min_u32 v128, -2, v128
    v_min_u32 v129, -2, v129
    v_min_u32 v130, -2, v130
    v_min_u32 v131, -2, v131
    buffer_store_dwordx4 v[128:131], v11, s[36:39], 0 offen sc1
    s_mov_b64 exec, -1
L_role_11:
    s_waitcnt vmcnt(4)
    buffer_load_dwordx4 v[184:187], v2, s[12:15], s50 offen offset:2048 nt
    s_waitcnt vmcnt(4)
    buffer_load_dwordx4 v[188:191], v2, s[12:15], s50 offen offset:3072 nt
    s_waitcnt vmcnt(4)
    buffer_load_dwordx4 v[192:195], v2, s[12:15], s51 offen offset:0 nt
    s_waitcnt vmcnt(4)
    buffer_load_dwordx4 v[196:199], v2, s[12:15], s51 offen offset:1024 nt
    s_waitcnt vmcnt(4)
    buffer_load_dwordx4 v[200:203], v2, s[12:15], s51 offen offset:2048 nt
    s_waitcnt vmcnt(4)
    buffer_load_dwordx4 v[204:207], v2, s[12:15], s51 offen offset:3072 nt
    s_lshl_b32 s69, s67, 10
    s_lshl_b32 s70, s66, 7
    s_add_u32 s69, s69, s70
    s_add_u32 s69, s69, 462848
    v_mov_b32 v11, s69
    buffer_load_dword v10, v11, s[36:39], 0 offen sc1
    s_waitcnt vmcnt(5)
    buffer_load_dwordx4 v[208:211], v2, s[12:15], s52 offen offset:0 nt
    v_perm_b32 v112, v164, v160, s57
    v_perm_b32 v113, v172, v168, s57
    v_perm_b32 v114, v180, v176, s57
    v_perm_b32 v115, v188, v184, s57
    v_perm_b32 v116, v164, v160, s58
    v_perm_b32 v117, v172, v168, s58
    v_perm_b32 v118, v180, v176, s58
    v_perm_b32 v119, v188, v184, s58
    v_mfma_f32_16x16x32_bf16 v[32:35], v[68:71], v[112:115], v[32:35]
    v_perm_b32 v112, v165, v161, s57
    v_perm_b32 v113, v173, v169, s57
    v_perm_b32 v114, v181, v177, s57
    v_perm_b32 v115, v189, v185, s57
    v_mfma_f32_16x16x32_bf16 v[36:39], v[68:71], v[116:119], v[36:39]
    v_perm_b32 v116, v165, v161, s58
    v_perm_b32 v117, v173, v169, s58
    v_perm_b32 v118, v181, v177, s58
    v_perm_b32 v119, v189, v185, s58
    v_mfma_f32_16x16x32_bf16 v[40:43], v[68:71], v[112:115], v[40:43]
    v_perm_b32 v112, v166, v162, s57
    v_perm_b32 v113, v174, v170, s57
    v_perm_b32 v114, v182, v178, s57
    v_perm_b32 v115, v190, v186, s57
    v_mfma_f32_16x16x32_bf16 v[44:47], v[68:71], v[116:119], v[44:47]
    v_perm_b32 v116, v166, v162, s58
    v_perm_b32 v117, v174, v170, s58
    v_perm_b32 v118, v182, v178, s58
    v_perm_b32 v119, v190, v186, s58
    v_mfma_f32_16x16x32_bf16 v[48:51], v[68:71], v[112:115], v[48:51]
    v_perm_b32 v112, v167, v163, s57
    v_perm_b32 v113, v175, v171, s57
    v_perm_b32 v114, v183, v179, s57
    v_perm_b32 v115, v191, v187, s57
    v_mfma_f32_16x16x32_bf16 v[52:55], v[68:71], v[116:119], v[52:55]
    v_perm_b32 v116, v167, v163, s58
    v_perm_b32 v117, v175, v171, s58
    v_perm_b32 v118, v183, v179, s58
    v_perm_b32 v119, v191, v187, s58
    v_mfma_f32_16x16x32_bf16 v[56:59], v[68:71], v[112:115], v[56:59]
    s_nop 0
    v_mfma_f32_16x16x32_bf16 v[60:63], v[68:71], v[116:119], v[60:63]
    s_waitcnt vmcnt(5)
    buffer_load_dwordx4 v[212:215], v2, s[12:15], s52 offen offset:1024 nt
    s_waitcnt vmcnt(5)
    buffer_load_dwordx4 v[216:219], v2, s[12:15], s52 offen offset:2048 nt
    s_waitcnt vmcnt(5)
    buffer_load_dwordx4 v[220:223], v2, s[12:15], s52 offen offset:3072 nt
    s_waitcnt vmcnt(5)
    buffer_load_dwordx4 v[224:227], v2, s[12:15], s53 offen offset:0 nt
    s_waitcnt vmcnt(5)
L_rchk_13:
    v_readfirstlane_b32 s70, v10
    s_nop 0
    s_cmp_ge_u32 s70, 64
    s_cbranch_scc1 L_rok_14
    s_cmp_eq_u32 s64, 0
    s_cbranch_scc1 L_rok_14
    s_sub_u32 s64, s64, 1
    s_sleep 8
    buffer_load_dword v10, v11, s[36:39], 0 offen sc1
    s_waitcnt vmcnt(0)
    s_branch L_rchk_13
L_rok_14:
    s_lshl_b32 s69, s65, 12
    s_lshl_b32 s70, s3, 6
    s_add_u32 s69, s69, s70
    s_add_u32 s69, s69, 131072
    v_lshrrev_b32 v124, 3, v6
    v_lshlrev_b32 v124, 17, v124
    v_and_b32 v125, 7, v6
    v_lshl_add_u32 v124, v125, 9, v124
    v_lshl_add_u32 v124, v5, 4, v124
    v_add_u32 v124, s69, v124
    buffer_load_dwordx4 v[120:123], v124, s[36:39], 0 offen sc1
    s_waitcnt vmcnt(5)
    buffer_load_dwordx4 v[228:231], v2, s[12:15], s53 offen offset:1024 nt
    s_waitcnt vmcnt(5)
    buffer_load_dwordx4 v[232:235], v2, s[12:15], s53 offen offset:2048 nt
    s_waitcnt vmcnt(5)
    buffer_load_dwordx4 v[236:239], v2, s[12:15], s53 offen offset:3072 nt
    s_movk_i32 s61, 8192
    buffer_load_dwordx4 v[128:131], v28, s[36:39], 0 offen sc1
    buffer_load_dwordx4 v[132:135], v28, s[36:39], s61 offen sc1
    s_waitcnt vmcnt(7)
    buffer_load_dwordx4 v[240:243], v2, s[12:15], s54 offen offset:0 nt
    v_perm_b32 v112, v196, v192, s57
    v_perm_b32 v113, v204, v200, s57
    v_perm_b32 v114, v212, v208, s57
    v_perm_b32 v115, v220, v216, s57
    v_perm_b32 v116, v196, v192, s58
    v_perm_b32 v117, v204, v200, s58
    v_perm_b32 v118, v212, v208, s58
    v_perm_b32 v119, v220, v216, s58
    v_mfma_f32_16x16x32_bf16 v[32:35], v[72:75], v[112:115], v[32:35]
    v_perm_b32 v112, v197, v193, s57
    v_perm_b32 v113, v205, v201, s57
    v_perm_b32 v114, v213, v209, s57
    v_perm_b32 v115, v221, v217, s57
    v_mfma_f32_16x16x32_bf16 v[36:39], v[72:75], v[116:119], v[36:39]
    v_perm_b32 v116, v197, v193, s58
    v_perm_b32 v117, v205, v201, s58
    v_perm_b32 v118, v213, v209, s58
    v_perm_b32 v119, v221, v217, s58
    v_mfma_f32_16x16x32_bf16 v[40:43], v[72:75], v[112:115], v[40:43]
    v_perm_b32 v112, v198, v194, s57
    v_perm_b32 v113, v206, v202, s57
    v_perm_b32 v114, v214, v210, s57
    v_perm_b32 v115, v222, v218, s57
    v_mfma_f32_16x16x32_bf16 v[44:47], v[72:75], v[116:119], v[44:47]
    v_perm_b32 v116, v198, v194, s58
    v_perm_b32 v117, v206, v202, s58
    v_perm_b32 v118, v214, v210, s58
    v_perm_b32 v119, v222, v218, s58
    v_mfma_f32_16x16x32_bf16 v[48:51], v[72:75], v[112:115], v[48:51]
    v_perm_b32 v112, v199, v195, s57
    v_perm_b32 v113, v207, v203, s57
    v_perm_b32 v114, v215, v211, s57
    v_perm_b32 v115, v223, v219, s57
    v_mfma_f32_16x16x32_bf16 v[52:55], v[72:75], v[116:119], v[52:55]
    v_perm_b32 v116, v199, v195, s58
    v_perm_b32 v117, v207, v203, s58
    v_perm_b32 v118, v215, v211, s58
    v_perm_b32 v119, v223, v219, s58
    v_mfma_f32_16x16x32_bf16 v[56:59], v[72:75], v[112:115], v[56:59]
    s_nop 0
    v_mfma_f32_16x16x32_bf16 v[60:63], v[72:75], v[116:119], v[60:63]
    s_waitcnt vmcnt(7)
    buffer_load_dwordx4 v[244:247], v2, s[12:15], s54 offen offset:1024 nt
    s_waitcnt vmcnt(7)
    v_add_f32_dpp v120, v120, v120 quad_perm:[1,0,3,2] row_mask:0xf bank_mask:0xf
    v_add_f32_dpp v121, v121, v121 quad_perm:[1,0,3,2] row_mask:0xf bank_mask:0xf
    v_add_f32_dpp v122, v122, v122 quad_perm:[1,0,3,2] row_mask:0xf bank_mask:0xf
    v_add_f32_dpp v123, v123, v123 quad_perm:[1,0,3,2] row_mask:0xf bank_mask:0xf
    v_add_f32_dpp v120, v120, v120 quad_perm:[2,3,0,1] row_mask:0xf bank_mask:0xf
    v_add_f32_dpp v121, v121, v121 quad_perm:[2,3,0,1] row_mask:0xf bank_mask:0xf
    v_add_f32_dpp v122, v122, v122 quad_perm:[2,3,0,1] row_mask:0xf bank_mask:0xf
    v_add_f32_dpp v123, v123, v123 quad_perm:[2,3,0,1] row_mask:0xf bank_mask:0xf
    v_add_f32_dpp v120, v120, v120 row_half_mirror row_mask:0xf bank_mask:0xf
    v_add_f32_dpp v121, v121, v121 row_half_mirror row_mask:0xf bank_mask:0xf
    v_add_f32_dpp v122, v122, v122 row_half_mirror row_mask:0xf bank_mask:0xf
    v_add_f32_dpp v123, v123, v123 row_half_mirror row_mask:0xf bank_mask:0xf
    v_mov_b32_dpp v124, v120 row_ror:8 row_mask:0xf bank_mask:0xf
    v_mov_b32_dpp v125, v121 row_ror:8 row_mask:0xf bank_mask:0xf
    v_mov_b32_dpp v126, v122 row_ror:8 row_mask:0xf bank_mask:0xf
    v_mov_b32_dpp v127, v123 row_ror:8 row_mask:0xf bank_mask:0xf
    v_cmp_gt_u32 vcc, 8, v6
    s_nop 1
    v_cndmask_b32 v20, v124, v120, vcc
    v_cndmask_b32 v120, v120, v124, vcc
    v_cndmask_b32 v21, v125, v121, vcc
    v_cndmask_b32 v121, v121, v125, vcc
    v_cndmask_b32 v22, v126, v122, vcc
    v_cndmask_b32 v122, v122, v126, vcc
    v_cndmask_b32 v23, v127, v123, vcc
    v_cndmask_b32 v123, v123, v127, vcc
    s_waitcnt vmcnt(6)
    buffer_load_dwordx4 v[248:251], v2, s[12:15], s54 offen offset:2048 nt
    v_cvt_pk_bf16_f32 v20, v20, v20
    v_and_b32 v20, s55, v20
    v_cvt_pk_bf16_f32 v120, v120, v120
    v_and_b32 v120, s55, v120
    v_cvt_pk_bf16_f32 v21, v21, v21
    v_and_b32 v21, s55, v21
    v_cvt_pk_bf16_f32 v121, v121, v121
    v_and_b32 v121, s55, v121
    v_cvt_pk_bf16_f32 v22, v22, v22
    v_and_b32 v22, s55, v22
    v_cvt_pk_bf16_f32 v122, v122, v122
    v_and_b32 v122, s55, v122
    v_cvt_pk_bf16_f32 v23, v23, v23
    v_and_b32 v23, s55, v23
    v_cvt_pk_bf16_f32 v123, v123, v123
    v_and_b32 v123, s55, v123
    v_mul_f32 v124, s59, v20
    v_exp_f32 v124, -v124
    s_nop 0
    v_add_f32 v124, 1.0, v124
    v_rcp_f32 v125, v124
    s_nop 0
    v_mul_f32 v20, v20, v125
    v_cvt_pk_bf16_f32 v20, v20, v20
    v_and_b32 v20, s55, v20
    v_mul_f32 v124, s59, v21
    v_exp_f32 v124, -v124
    s_nop 0
    v_add_f32 v124, 1.0, v124
    v_rcp_f32 v125, v124
    s_nop 0
    v_mul_f32 v21, v21, v125
    v_cvt_pk_bf16_f32 v21, v21, v21
    v_and_b32 v21, s55, v21
    s_waitcnt vmcnt(6)
    buffer_load_dwordx4 v[252:255], v2, s[12:15], s54 offen offset:3072 nt
    v_mul_f32 v124, s59, v22
    v_exp_f32 v124, -v124
    s_nop 0
    v_add_f32 v124, 1.0, v124
    v_rcp_f32 v125, v124
    s_nop 0
    v_mul_f32 v22, v22, v125
    v_cvt_pk_bf16_f32 v22, v22, v22
    v_and_b32 v22, s55, v22
    v_mul_f32 v124, s59, v23
    v_exp_f32 v124, -v124
    s_nop 0
    v_add_f32 v124, 1.0, v124
    v_rcp_f32 v125, v124
    s_nop 0
    v_mul_f32 v23, v23, v125
    v_cvt_pk_bf16_f32 v23, v23, v23
    v_and_b32 v23, s55, v23
    v_mul_f32 v20, v20, v120
    v_mul_f32 v21, v21, v121
    v_mul_f32 v22, v22, v122
    v_mul_f32 v23, v23, v123
    v_cvt_pk_bf16_f32 v20, v20, v20
    v_cvt_pk_bf16_f32 v21, v21, v21
    v_cvt_pk_bf16_f32 v22, v22, v22
    v_cvt_pk_bf16_f32 v23, v23, v23
    buffer_load_dwordx4 v[80:83], v3, s[28:31], 0 offen nt
    s_waitcnt vmcnt(7)
    buffer_load_dwordx4 v[84:87], v3, s[28:31], 0 offen offset:2048 nt
    s_waitcnt vmcnt(5)
    buffer_load_dwordx4 v[88:91], v3, s[28:31], s73 offen nt
    s_waitcnt vmcnt(5)
    buffer_load_dwordx4 v[92:95], v3, s[28:31], s73 offen offset:2048 nt
L_mchk_15:
    v_max3_u32 v136, v128, v129, v130
    v_max3_u32 v137, v131, v132, v133
    v_max3_u32 v136, v136, v134, v135
    v_max_u32 v136, v136, v137
    v_cmp_eq_u32 vcc, -1, v136
    s_cbranch_vccz L_mok_16
    s_cmp_eq_u32 s64, 0
    s_cbranch_scc1 L_mok_16
    s_sub_u32 s64, s64, 1
    s_sleep 8
    buffer_load_dwordx4 v[128:131], v28, s[36:39], 0 offen sc1
    buffer_load_dwordx4 v[132:135], v28, s[36:39], s61 offen sc1
    s_waitcnt vmcnt(0)
    s_branch L_mchk_15
L_mok_16:
    v_mov_b32 v136, v128
    v_mov_b32 v137, v129
    v_mov_b32 v138, v130
    v_mov_b32 v139, v131
    v_max_f32_dpp v136, v136, v136 row_ror:8 row_mask:0xf bank_mask:0xf
    v_max_f32_dpp v137, v137, v137 row_ror:8 row_mask:0xf bank_mask:0xf
    v_max_f32_dpp v138, v138, v138 row_ror:8 row_mask:0xf bank_mask:0xf
    v_max_f32_dpp v139, v139, v139 row_ror:8 row_mask:0xf bank_mask:0xf
    v_max_f32_dpp v136, v136, v136 row_ror:4 row_mask:0xf bank_mask:0xf
    v_max_f32_dpp v137, v137, v137 row_ror:4 row_mask:0xf bank_mask:0xf
    v_max_f32_dpp v138, v138, v138 row_ror:4 row_mask:0xf bank_mask:0xf
    v_max_f32_dpp v139, v139, v139 row_ror:4 row_mask:0xf bank_mask:0xf
    v_max_f32_dpp v136, v136, v136 row_ror:2 row_mask:0xf bank_mask:0xf
    v_max_f32_dpp v137, v137, v137 row_ror:2 row_mask:0xf bank_mask:0xf
    v_max_f32_dpp v138, v138, v138 row_ror:2 row_mask:0xf bank_mask:0xf
    v_max_f32_dpp v139, v139, v139 row_ror:2 row_mask:0xf bank_mask:0xf
    v_max_f32_dpp v136, v136, v136 row_ror:1 row_mask:0xf bank_mask:0xf
    v_max_f32_dpp v137, v137, v137 row_ror:1 row_mask:0xf bank_mask:0xf
    v_max_f32_dpp v138, v138, v138 row_ror:1 row_mask:0xf bank_mask:0xf
    v_max_f32_dpp v139, v139, v139 row_ror:1 row_mask:0xf bank_mask:0xf
    v_mov_b32 v140, v136
    v_mov_b32 v141, v137
    v_mov_b32 v142, v138
    v_mov_b32 v143, v139
    v_permlane16_swap_b32 v136, v140
    v_permlane16_swap_b32 v137, v141
    v_permlane16_swap_b32 v138, v142
    v_permlane16_swap_b32 v139, v143
    v_max_f32 v136, v136, v140
    v_max_f32 v137, v137, v141
    v_max_f32 v138, v138, v142
    v_max_f32 v139, v139, v143
    v_mov_b32 v140, v136
    v_mov_b32 v141, v137
    v_mov_b32 v142, v138
    v_mov_b32 v143, v139
    v_permlane32_swap_b32 v136, v140
    v_permlane32_swap_b32 v137, v141
    v_permlane32_swap_b32 v138, v142
    v_permlane32_swap_b32 v139, v143
    v_max_f32 v136, v136, v140
    v_max_f32 v137, v137, v141
    v_max_f32 v138, v138, v142
    v_max_f32 v139, v139, v143
    v_sub_f32 v128, v128, v136
    v_sub_f32 v129, v129, v137
    v_sub_f32 v130, v130, v138
    v_sub_f32 v131, v131, v139
    v_exp_f32 v128, v128
    v_exp_f32 v129, v129
    v_exp_f32 v130, v130
    v_exp_f32 v131, v131
    v_mul_f32 v136, v128, v132
    v_mul_f32 v137, v129, v133
    v_mul_f32 v138, v130, v134
    v_mul_f32 v139, v131, v135
    v_add_f32_dpp v136, v136, v136 row_ror:8 row_mask:0xf bank_mask:0xf
    v_add_f32_dpp v137, v137, v137 row_ror:8 row_mask:0xf bank_mask:0xf
    v_add_f32_dpp v138, v138, v138 row_ror:8 row_mask:0xf bank_mask:0xf
    v_add_f32_dpp v139, v139, v139 row_ror:8 row_mask:0xf bank_mask:0xf
    v_add_f32_dpp v136, v136, v136 row_ror:4 row_mask:0xf bank_mask:0xf
    v_add_f32_dpp v137, v137, v137 row_ror:4 row_mask:0xf bank_mask:0xf
    v_add_f32_dpp v138, v138, v138 row_ror:4 row_mask:0xf bank_mask:0xf
    v_add_f32_dpp v139, v139, v139 row_ror:4 row_mask:0xf bank_mask:0xf
    v_add_f32_dpp v136, v136, v136 row_ror:2 row_mask:0xf bank_mask:0xf
    v_add_f32_dpp v137, v137, v137 row_ror:2 row_mask:0xf bank_mask:0xf
    v_add_f32_dpp v138, v138, v138 row_ror:2 row_mask:0xf bank_mask:0xf
    v_add_f32_dpp v139, v139, v139 row_ror:2 row_mask:0xf bank_mask:0xf
    v_add_f32_dpp v136, v136, v136 row_ror:1 row_mask:0xf bank_mask:0xf
    v_add_f32_dpp v137, v137, v137 row_ror:1 row_mask:0xf bank_mask:0xf
    v_add_f32_dpp v138, v138, v138 row_ror:1 row_mask:0xf bank_mask:0xf
    v_add_f32_dpp v139, v139, v139 row_ror:1 row_mask:0xf bank_mask:0xf
    v_mov_b32 v140, v136
    v_mov_b32 v141, v137
    v_mov_b32 v142, v138
    v_mov_b32 v143, v139
    v_permlane16_swap_b32 v136, v140
    v_permlane16_swap_b32 v137, v141
    v_permlane16_swap_b32 v138, v142
    v_permlane16_swap_b32 v139, v143
    v_add_f32 v136, v136, v140
    v_add_f32 v137, v137, v141
    v_add_f32 v138, v138, v142
    v_add_f32 v139, v139, v143
    v_mov_b32 v140, v136
    v_mov_b32 v141, v137
    v_mov_b32 v142, v138
    v_mov_b32 v143, v139
    v_permlane32_swap_b32 v136, v140
    v_permlane32_swap_b32 v137, v141
    v_permlane32_swap_b32 v138, v142
    v_permlane32_swap_b32 v139, v143
    v_add_f32 v136, v136, v140
    v_add_f32 v137, v137, v141
    v_add_f32 v138, v138, v142
    v_add_f32 v139, v139, v143
    v_rcp_f32 v132, v136
    v_rcp_f32 v133, v137
    v_rcp_f32 v134, v138
    v_rcp_f32 v135, v139
    v_fma_f32 v136, -v136, v132, 1.0
    v_fma_f32 v137, -v137, v133, 1.0
    v_fma_f32 v138, -v138, v134, 1.0
    v_fma_f32 v139, -v139, v135, 1.0
    v_fmac_f32 v132, v136, v132
    v_fmac_f32 v133, v137, v133
    v_fmac_f32 v134, v138, v134
    v_fmac_f32 v135, v139, v135
    v_mul_f32 v128, v128, v132
    v_mul_f32 v129, v129, v133
    v_mul_f32 v130, v130, v134
    v_mul_f32 v131, v131, v135
    s_lshl_b32 s69, s3, 10
    v_lshl_add_u32 v136, v0, 4, s69
    v_lshl_add_u32 v137, v6, 4, s69
    ds_write_b128 v136, v[128:131] offset:4096
    s_waitcnt lgkmcnt(0)
    ds_read_b128 v[144:147], v137 offset:4096
    ds_read_b128 v[148:151], v137 offset:4352
    ds_read_b128 v[152:155], v137 offset:4608
    ds_read_b128 v[156:159], v137 offset:4864
    s_waitcnt vmcnt(4)
    v_perm_b32 v112, v228, v224, s57
    v_perm_b32 v113, v236, v232, s57
    v_perm_b32 v114, v244, v240, s57
    v_perm_b32 v115, v252, v248, s57
    v_perm_b32 v116, v228, v224, s58
    v_perm_b32 v117, v236, v232, s58
    v_perm_b32 v118, v244, v240, s58
    v_perm_b32 v119, v252, v248, s58
    v_mfma_f32_16x16x32_bf16 v[32:35], v[76:79], v[112:115], v[32:35]
    v_perm_b32 v112, v229, v225, s57
    v_perm_b32 v113, v237, v233, s57
    v_perm_b32 v114, v245, v241, s57
    v_perm_b32 v115, v253, v249, s57
    v_mfma_f32_16x16x32_bf16 v[36:39], v[76:79], v[116:119], v[36:39]
    v_perm_b32 v116, v229, v225, s58
    v_perm_b32 v117, v237, v233, s58
    v_perm_b32 v118, v245, v241, s58
    v_perm_b32 v119, v253, v249, s58
    v_mfma_f32_16x16x32_bf16 v[40:43], v[76:79], v[112:115], v[40:43]
    v_perm_b32 v112, v230, v226, s57
    v_perm_b32 v113, v238, v234, s57
    v_perm_b32 v114, v246, v242, s57
    v_perm_b32 v115, v254, v250, s57
    v_mfma_f32_16x16x32_bf16 v[44:47], v[76:79], v[116:119], v[44:47]
    v_perm_b32 v116, v230, v226, s58
    v_perm_b32 v117, v238, v234, s58
    v_perm_b32 v118, v246, v242, s58
    v_perm_b32 v119, v254, v250, s58
    v_mfma_f32_16x16x32_bf16 v[48:51], v[76:79], v[112:115], v[48:51]
    v_perm_b32 v112, v231, v227, s57
    v_perm_b32 v113, v239, v235, s57
    v_perm_b32 v114, v247, v243, s57
    v_perm_b32 v115, v255, v251, s57
    v_mfma_f32_16x16x32_bf16 v[52:55], v[76:79], v[116:119], v[52:55]
    v_perm_b32 v116, v231, v227, s58
    v_perm_b32 v117, v239, v235, s58
    v_perm_b32 v118, v247, v243, s58
    v_perm_b32 v119, v255, v251, s58
    v_mfma_f32_16x16x32_bf16 v[56:59], v[76:79], v[112:115], v[56:59]
    s_nop 0
    v_mfma_f32_16x16x32_bf16 v[60:63], v[76:79], v[116:119], v[60:63]
    s_mov_b32 exec_hi, 0
    ds_write_b128 v24, v[32:35] offset:24576
    ds_write_b128 v24, v[36:39] offset:24608
    ds_write_b128 v24, v[40:43] offset:24640
    ds_write_b128 v24, v[44:47] offset:24672
    ds_write_b128 v24, v[48:51] offset:24704
    ds_write_b128 v24, v[52:55] offset:24736
    ds_write_b128 v24, v[56:59] offset:24768
    ds_write_b128 v24, v[60:63] offset:24800
    s_mov_b32 exec_hi, -1
    s_waitcnt lgkmcnt(0)
    s_barrier
    s_cmp_lt_u32 s3, 4
    s_cbranch_scc0 L_pub_17
    ds_read_b128 v[224:227], v25 offset:24576
    ds_read_b128 v[228:231], v25 offset:28928
    ds_read_b128 v[232:235], v25 offset:33280
    ds_read_b128 v[236:239], v25 offset:37632
    ds_read_b128 v[240:243], v25 offset:41984
    ds_read_b128 v[244:247], v25 offset:46336
    ds_read_b128 v[248:251], v25 offset:50688
    ds_read_b128 v[252:255], v25 offset:55040
    s_waitcnt lgkmcnt(0)
    v_add_f32 v224, v224, v228
    v_add_f32 v225, v225, v229
    v_add_f32 v226, v226, v230
    v_add_f32 v227, v227, v231
    v_add_f32 v232, v232, v236
    v_add_f32 v233, v233, v237
    v_add_f32 v234, v234, v238
    v_add_f32 v235, v235, v239
    v_add_f32 v240, v240, v244
    v_add_f32 v241, v241, v245
    v_add_f32 v242, v242, v246
    v_add_f32 v243, v243, v247
    v_add_f32 v248, v248, v252
    v_add_f32 v249, v249, v253
    v_add_f32 v250, v250, v254
    v_add_f32 v251, v251, v255
    v_add_f32 v224, v224, v232
    v_add_f32 v225, v225, v233
    v_add_f32 v226, v226, v234
    v_add_f32 v227, v227, v235
    v_add_f32 v240, v240, v248
    v_add_f32 v241, v241, v249
    v_add_f32 v242, v242, v250
    v_add_f32 v243, v243, v251
    v_add_f32 v224, v224, v240
    v_add_f32 v225, v225, v241
    v_add_f32 v226, v226, v242
    v_add_f32 v227, v227, v243
    buffer_store_dwordx4 v[224:227], v26, s[36:39], 0 offen sc1
L_pub_17:
    s_barrier
    buffer_load_dwordx4 v[96:99], v4, s[32:35], 0 offen nt
    buffer_load_dwordx4 v[100:103], v4, s[32:35], s74 offen nt
    buffer_load_dwordx4 v[104:107], v4, s[32:35], s75 offen nt
    buffer_load_dwordx4 v[108:111], v4, s[32:35], s72 offen nt
    s_waitcnt vmcnt(4)
    s_barrier
    s_cmp_eq_u32 s3, 0
    s_cbranch_scc0 L_role_18
    s_lshl_b32 s69, s67, 10
    s_add_u32 s69, s69, 458752
    v_lshl_add_u32 v10, v0, 7, s69
    v_mov_b32 v11, 1
    s_mov_b64 exec, 0xff
    buffer_atomic_add v11, v10, s[36:39], 0 offen
    s_mov_b64 exec, -1
L_role_18:
    v_and_b32 v176, v20, v16
    v_and_b32 v177, v20, v17
    v_and_b32 v178, v20, v18
    v_and_b32 v179, v20, v19
    v_and_b32 v180, v21, v16
    v_and_b32 v181, v21, v17
    v_and_b32 v182, v21, v18
    v_and_b32 v183, v21, v19
    v_and_b32 v184, v22, v16
    v_and_b32 v185, v22, v17
    v_and_b32 v186, v22, v18
    v_and_b32 v187, v22, v19
    v_and_b32 v188, v23, v16
    v_and_b32 v189, v23, v17
    v_and_b32 v190, v23, v18
    v_and_b32 v191, v23, v19
    s_waitcnt vmcnt(7)
    v_mfma_f32_16x16x32_bf16 v[208:211], v[176:179], v[80:83], 0
    s_waitcnt vmcnt(6)
    v_mfma_f32_16x16x32_bf16 v[208:211], v[180:183], v[84:87], v[208:211]
    s_waitcnt vmcnt(5)
    v_mfma_f32_16x16x32_bf16 v[208:211], v[184:187], v[88:91], v[208:211]
    s_waitcnt vmcnt(4)
    v_mfma_f32_16x16x32_bf16 v[208:211], v[188:191], v[92:95], v[208:211]
    s_mov_b32 exec_hi, 0
    s_nop 6
    ds_write_b128 v7, v[208:211] offset:16384
    s_mov_b32 exec_hi, -1
    s_cmp_eq_u32 s3, 0
    s_cbranch_scc0 L_role_19
    s_lshl_b32 s70, s66, 7
    s_add_u32 s70, s70, 462848
    v_and_b32 v21, 3, v0
    v_lshl_add_u32 v21, v21, 10, s70
    buffer_load_dword v20, v21, s[36:39], 0 offen sc1
L_role_19:
    s_cmp_eq_u32 s3, 0
    s_cbranch_scc0 L_role_20
    s_lshl_b32 s69, s67, 10
    s_lshl_b32 s70, s66, 7
    s_add_u32 s69, s69, s70
    s_add_u32 s69, s69, 458752
    v_mov_b32 v10, s69
    s_mov_b64 exec, 1
L_ochk_21:
    buffer_load_dword v11, v10, s[36:39], 0 offen sc1
    s_waitcnt vmcnt(0)
    v_readfirstlane_b32 s70, v11
    s_nop 0
    s_cmp_ge_u32 s70, 64
    s_cbranch_scc1 L_ook_22
    s_cmp_eq_u32 s64, 0
    s_cbranch_scc1 L_ook_22
    s_sub_u32 s64, s64, 1
    s_sleep 1
    s_branch L_ochk_21
L_ook_22:
    s_mov_b64 exec, -1
L_role_20:
    s_barrier
    buffer_load_dwordx4 v[192:195], v27, s[36:39], 0 offen offset:0 sc1
    buffer_load_dwordx4 v[196:199], v27, s[36:39], 0 offen offset:1024 sc1
    buffer_load_dwordx4 v[200:203], v27, s[36:39], 0 offen offset:2048 sc1
    buffer_load_dwordx4 v[204:207], v27, s[36:39], 0 offen offset:3072 sc1
    s_waitcnt vmcnt(0)
    v_mul_f32 v220, v144, v192
    v_mul_f32 v221, v145, v193
    v_mul_f32 v222, v146, v194
    v_mul_f32 v223, v147, v195
    v_fmac_f32 v220, v148, v196
    v_fmac_f32 v221, v149, v197
    v_fmac_f32 v222, v150, v198
    v_fmac_f32 v223, v151, v199
    v_fmac_f32 v220, v152, v200
    v_fmac_f32 v221, v153, v201
    v_fmac_f32 v222, v154, v202
    v_fmac_f32 v223, v155, v203
    v_fmac_f32 v220, v156, v204
    v_fmac_f32 v221, v157, v205
    v_fmac_f32 v222, v158, v206
    v_fmac_f32 v223, v159, v207
    v_add_f32_dpp v220, v220, v220 row_ror:8 row_mask:0xf bank_mask:0xf
    v_add_f32_dpp v221, v221, v221 row_ror:8 row_mask:0xf bank_mask:0xf
    v_add_f32_dpp v222, v222, v222 row_ror:8 row_mask:0xf bank_mask:0xf
    v_add_f32_dpp v223, v223, v223 row_ror:8 row_mask:0xf bank_mask:0xf
    v_add_f32_dpp v220, v220, v220 row_ror:4 row_mask:0xf bank_mask:0xf
    v_add_f32_dpp v221, v221, v221 row_ror:4 row_mask:0xf bank_mask:0xf
    v_add_f32_dpp v222, v222, v222 row_ror:4 row_mask:0xf bank_mask:0xf
    v_add_f32_dpp v223, v223, v223 row_ror:4 row_mask:0xf bank_mask:0xf
    v_add_f32_dpp v220, v220, v220 row_ror:2 row_mask:0xf bank_mask:0xf
    v_add_f32_dpp v221, v221, v221 row_ror:2 row_mask:0xf bank_mask:0xf
    v_add_f32_dpp v222, v222, v222 row_ror:2 row_mask:0xf bank_mask:0xf
    v_add_f32_dpp v223, v223, v223 row_ror:2 row_mask:0xf bank_mask:0xf
    v_add_f32_dpp v220, v220, v220 row_ror:1 row_mask:0xf bank_mask:0xf
    v_add_f32_dpp v221, v221, v221 row_ror:1 row_mask:0xf bank_mask:0xf
    v_add_f32_dpp v222, v222, v222 row_ror:1 row_mask:0xf bank_mask:0xf
    v_add_f32_dpp v223, v223, v223 row_ror:1 row_mask:0xf bank_mask:0xf
    v_cvt_pk_bf16_f32 v220, v220, v220
    v_cvt_pk_bf16_f32 v221, v221, v221
    v_cvt_pk_bf16_f32 v222, v222, v222
    v_cvt_pk_bf16_f32 v223, v223, v223
    v_and_b32 v176, v220, v16
    v_and_b32 v177, v220, v17
    v_and_b32 v178, v220, v18
    v_and_b32 v179, v220, v19
    v_and_b32 v180, v221, v16
    v_and_b32 v181, v221, v17
    v_and_b32 v182, v221, v18
    v_and_b32 v183, v221, v19
    v_and_b32 v184, v222, v16
    v_and_b32 v185, v222, v17
    v_and_b32 v186, v222, v18
    v_and_b32 v187, v222, v19
    v_and_b32 v188, v223, v16
    v_and_b32 v189, v223, v17
    v_and_b32 v190, v223, v18
    v_and_b32 v191, v223, v19
    v_mfma_f32_16x16x32_bf16 v[212:215], v[176:179], v[96:99], 0
    v_mfma_f32_16x16x32_bf16 v[212:215], v[180:183], v[100:103], v[212:215]
    v_mfma_f32_16x16x32_bf16 v[212:215], v[184:187], v[104:107], v[212:215]
    v_mfma_f32_16x16x32_bf16 v[212:215], v[188:191], v[108:111], v[212:215]
    v_and_b32 v10, 31, v0
    v_lshlrev_b32 v10, 4, v10
    v_lshrrev_b32 v11, 5, v0
    v_lshl_add_u32 v10, v11, 12, v10
    s_mov_b32 exec_hi, 0
    s_nop 2
    ds_write_b128 v7, v[212:215] offset:12288
    s_mov_b32 exec_hi, -1
    s_waitcnt lgkmcnt(0)
    s_barrier
    s_cmp_eq_u32 s3, 0
    s_cbranch_scc0 L_role_23
    ds_read_b128 v[224:227], v10 offset:12288
    ds_read_b128 v[228:231], v10 offset:12800
    ds_read_b128 v[232:235], v10 offset:13312
    ds_read_b128 v[236:239], v10 offset:13824
    ds_read_b128 v[240:243], v10 offset:14336
    ds_read_b128 v[244:247], v10 offset:14848
    ds_read_b128 v[248:251], v10 offset:15360
    ds_read_b128 v[252:255], v10 offset:15872
    s_waitcnt lgkmcnt(0)
    v_add_f32 v224, v224, v228
    v_add_f32 v225, v225, v229
    v_add_f32 v226, v226, v230
    v_add_f32 v227, v227, v231
    v_add_f32 v232, v232, v236
    v_add_f32 v233, v233, v237
    v_add_f32 v234, v234, v238
    v_add_f32 v235, v235, v239
    v_add_f32 v240, v240, v244
    v_add_f32 v241, v241, v245
    v_add_f32 v242, v242, v246
    v_add_f32 v243, v243, v247
    v_add_f32 v248, v248, v252
    v_add_f32 v249, v249, v253
    v_add_f32 v250, v250, v254
    v_add_f32 v251, v251, v255
    v_add_f32 v224, v224, v232
    v_add_f32 v225, v225, v233
    v_add_f32 v226, v226, v234
    v_add_f32 v227, v227, v235
    v_add_f32 v240, v240, v248
    v_add_f32 v241, v241, v249
    v_add_f32 v242, v242, v250
    v_add_f32 v243, v243, v251
    v_add_f32 v224, v224, v240
    v_add_f32 v225, v225, v241
    v_add_f32 v226, v226, v242
    v_add_f32 v227, v227, v243
    v_min_u32 v224, -2, v224
    v_min_u32 v225, -2, v225
    v_min_u32 v226, -2, v226
    v_min_u32 v227, -2, v227
    buffer_store_dwordx4 v[224:227], v29, s[36:39], 0 offen sc1
    s_waitcnt vmcnt(0)
L_role_23:
    s_cmp_eq_u32 s3, 0
    s_cbranch_scc0 L_role_24
L_achk_25:
    v_cmp_le_u32 vcc, 64, v20
    s_nop 0
    s_and_b32 s69, vcc_lo, 15
    s_cmp_eq_u32 s69, 15
    s_cbranch_scc1 L_aok_26
    s_cmp_eq_u32 s64, 0
    s_cbranch_scc1 L_aok_26
    s_sub_u32 s64, s64, 1
    s_sleep 8
    buffer_load_dword v20, v21, s[36:39], 0 offen sc1
    s_waitcnt vmcnt(0)
    s_branch L_achk_25
L_aok_26:
    s_mov_b32 s48, 0xaaaaaaaa
    s_mov_b32 s49, 0xaaaaaaaa
    s_mov_b32 s50, 0xcccccccc
    s_mov_b32 s51, 0xcccccccc
    v_lshlrev_b32 v9, 16, v9
L_cchk_27:
    buffer_load_dwordx4 v[128:131], v30, s[36:39], 0 offen sc1
    s_mov_b64 exec, -1
    s_waitcnt vmcnt(0)
    v_max3_u32 v11, v128, v129, v130
    v_max_u32 v11, v11, v131
    v_cmp_eq_u32 vcc, -1, v11
    s_cbranch_vccz L_cok_28
    s_cmp_eq_u32 s64, 0
    s_cbranch_scc1 L_cok_28
    s_sub_u32 s64, s64, 1
    s_mov_b64 exec, vcc
    s_branch L_cchk_27
L_cok_28:
    v_cndmask_b32 v132, v128, v130, s[48:49]
    v_cndmask_b32 v133, v129, v131, s[48:49]
    v_cndmask_b32 v134, v130, v128, s[48:49]
    v_cndmask_b32 v135, v131, v129, s[48:49]
    s_nop 0
    v_add_f32_dpp v132, v134, v132 quad_perm:[1,0,3,2] row_mask:0xf bank_mask:0xf
    v_add_f32_dpp v133, v135, v133 quad_perm:[1,0,3,2] row_mask:0xf bank_mask:0xf
    v_cndmask_b32 v128, v132, v133, s[50:51]
    v_cndmask_b32 v129, v133, v132, s[50:51]
    s_nop 1
    v_add_f32_dpp v128, v129, v128 quad_perm:[2,3,0,1] row_mask:0xf bank_mask:0xf
    s_nop 1
    v_add_f32_dpp v128, v128, v128 row_ror:4 row_mask:0xf bank_mask:0xf
    s_nop 1
    v_add_f32_dpp v128, v128, v128 row_ror:8 row_mask:0xf bank_mask:0xf
    v_mov_b32 v129, v128
    s_nop 1
    v_permlane16_swap_b32 v128, v129
    v_add_f32 v128, v128, v129
    v_mov_b32 v129, v128
    s_nop 1
    v_permlane32_swap_b32 v128, v129
    v_cvt_pk_bf16_f32 v128, v128, v128
    v_and_b32 v128, s55, v128
    v_cvt_pk_bf16_f32 v129, v129, v129
    v_and_b32 v129, s55, v129
    v_mul_f32 v132, s59, v129
    v_exp_f32 v132, -v132
    s_nop 0
    v_add_f32 v132, 1.0, v132
    v_rcp_f32 v133, v132
    s_nop 0
    v_mul_f32 v130, v129, v133
    v_cvt_pk_bf16_f32 v130, v130, v130
    v_and_b32 v130, s55, v130
    v_mul_f32 v128, v128, v130
    v_cvt_pk_bf16_f32 v128, v128, v128
    v_and_b32 v128, s55, v128
    v_add_f32 v128, v128, v9
    v_cvt_pk_bf16_f32 v128, v128, v128
    s_mov_b64 exec, 0xf
    buffer_store_short v128, v31, s[40:43], 0 offen
    s_mov_b64 exec, -1
L_role_24:
L_end:
    s_endpgm
.section .rodata,"a"
.p2align 6
.amdhsa_kernel recurrent_scan__gqa_block_cached__glu_gated_swiglu__decode_kernel
  .amdhsa_next_free_vgpr 256
  .amdhsa_next_free_sgpr 102
  .amdhsa_accum_offset 256
  .amdhsa_group_segment_fixed_size 0
  .amdhsa_kernarg_size 96
  .amdhsa_user_sgpr_count 2
  .amdhsa_user_sgpr_kernarg_segment_ptr 1
  .amdhsa_system_sgpr_workgroup_id_x 1
  .amdhsa_float_denorm_mode_32 3
  .amdhsa_float_denorm_mode_16_64 3
.end_amdhsa_kernel
```
